```python
import torch

def _softmax(x, axis=-1):
    return torch.softmax(x, dim=axis)
def _gelu(x):
    return torch.nn.functional.gelu(x, approximate="tanh")
def _silu(x):
    return torch.nn.functional.silu(x)
def _sigmoid(x):
    return torch.sigmoid(x)
def _layernorm(x, axis=-1, eps=1e-5):
    m = x.mean(dim=axis, keepdim=True)
    v = x.var(dim=axis, keepdim=True, unbiased=False)
    return (x - m) / torch.sqrt(v + eps)
def _scatter_add(tgt, idx, src, axis=0):
    return tgt.clone().index_add_(axis, idx, src)
def _segment_sum(src, seg, n):
    out = torch.zeros((n,) + src.shape[1:], dtype=src.dtype)
    return out.index_add_(0, seg, src)
def _pad(x, pw):
    flat = tuple(v for pair in reversed(pw) for v in pair)
    return torch.nn.functional.pad(x, flat)

kernel_name = 'standalone__low_rank_proj_linformer__decode'

def setup_inputs():

    _w = (lambda a: (lambda t: t.to(torch.bfloat16) if t.is_floating_point() else t)(torch.as_tensor(a)))
    B, H, Sq, Skv, Dh, R = 2, 16, 1, 8192, 256, 16
    return {
        "q": _w((lambda *s: torch.randn(*s, dtype=torch.bfloat16) * 0.8)(B, H, Sq, Dh)),
        "k": _w((lambda *s: torch.randn(*s, dtype=torch.bfloat16) * 0.8)(B, H, Skv, Dh)),
        "v": _w((lambda *s: torch.randn(*s, dtype=torch.bfloat16) * 0.05)(B, H, Skv, Dh)),
        "e_proj": _w((lambda *s: torch.randn(*s, dtype=torch.bfloat16) * 0.8)(R, Skv) * (Skv ** -0.5)),
        "f_proj": _w((lambda *s: torch.randn(*s, dtype=torch.bfloat16) * 0.05)(R, Skv) * (Skv ** -0.5)),
    }

def reference(q, k, v, e_proj, f_proj):
    B, H, Sq, Dh = q.shape
    kp = torch.einsum("rn,bhnd->bhrd", e_proj, k)
    vp = torch.einsum("rn,bhnd->bhrd", f_proj, v)
    scores = torch.einsum("bhqd,bhrd->bhqr", q, kp) * (Dh ** -0.5)
    p = _softmax(scores, axis=-1)
    o = torch.einsum("bhqr,bhrd->bhqd", p, vp)
    return o
```

```asm
; @launch grid=(256,1,1) block=(128,1,1) lds=256
.amdgcn_target "amdgcn-amd-amdhsa--gfx950"
.text
.globl standalone__low_rank_proj_linformer__decode_kernel
.p2align 8
.type standalone__low_rank_proj_linformer__decode_kernel,@function
standalone__low_rank_proj_linformer__decode_kernel:
    s_load_dwordx16 s[40:55], s[0:1], 0
    s_cmp_ge_u32 s2, 256
    s_cbranch_scc1 L_end
    s_getpc_b64 s[94:95]
L_pc:
    s_lshr_b32 s56, s2, 3
    s_mul_i32 s56, s56, 4
    v_add_lshl_u32 v184, v0, s56, 7
    v_min_u32 v184, L_last - L_pc, v184
    v_mov_b32 v185, 0
    v_lshl_add_u64 v[184:185], v[184:185], 0, s[94:95]
    s_mov_b64 exec, 15
    global_load_dword v186, v[184:185], off
    s_mov_b64 exec, -1
    v_and_b32 v4, 15, v0
    v_bfe_u32 v5, v0, 4, 2
    v_lshrrev_b32 v6, 6, v0
    v_lshlrev_b32 v10, 4, v4
    v_lshl_add_u32 v10, v6, 8, v10
    v_lshl_add_u32 v1, v5, 12, v10
    v_lshlrev_b32 v2, 4, v5
    v_lshl_add_u32 v2, v4, 14, v2
    s_mov_b32 s6, 0x8000000
    s_mov_b32 s7, 0x20000
    s_mov_b32 s14, 0x40000
    s_mov_b32 s15, 0x20000
    s_lshr_b32 s72, s2, 1
    s_lshl_b32 s72, s72, 20
    s_and_b32 s56, s2, 1
    s_lshl_b32 s56, s56, 15
    s_or_b32 s72, s72, s56
    s_bfe_u32 s74, s2, 0x40003
    s_lshl_b32 s74, s74, 16
    s_or_b32 s72, s72, s74
    s_mov_b32 s73, 0
    s_mov_b32 s38, s72
    s_bfe_u32 s39, s38, 0xe0008
    s_waitcnt lgkmcnt(0)
    s_mov_b64 s[4:5], s[42:43]
    s_mov_b64 s[12:13], s[46:47]
    buffer_load_dwordx4 v[96:99], v1, s[4:7], s38 offen offset:0 nt
    buffer_load_dwordx4 v[100:103], v1, s[4:7], s38 offen offset:512 nt
    buffer_load_dwordx4 v[104:107], v1, s[4:7], s38 offen offset:1024 nt
    buffer_load_dwordx4 v[108:111], v1, s[4:7], s38 offen offset:1536 nt
    buffer_load_dwordx4 v[112:115], v1, s[4:7], s38 offen offset:2048 nt
    buffer_load_dwordx4 v[116:119], v1, s[4:7], s38 offen offset:2560 nt
    buffer_load_dwordx4 v[24:27], v2, s[12:15], s39 offen
    buffer_load_dwordx4 v[120:123], v1, s[4:7], s38 offen offset:3072 nt
    buffer_load_dwordx4 v[124:127], v1, s[4:7], s38 offen offset:3584 nt
    s_add_u32 s73, s73, 0x4000
    s_xor_b32 s38, s73, s72
    s_bfe_u32 s39, s38, 0xe0008
    buffer_load_dwordx4 v[128:131], v1, s[4:7], s38 offen offset:0 nt
    buffer_load_dwordx4 v[132:135], v1, s[4:7], s38 offen offset:512 nt
    buffer_load_dwordx4 v[136:139], v1, s[4:7], s38 offen offset:1024 nt
    s_getreg_b32 s91, hwreg(HW_REG_XCC_ID)
    s_mov_b32 s36, 0x05040100
    s_mov_b32 s37, 0x07060302
    v_mov_b64 v[32:33], 0
    v_mov_b64 v[34:35], 0
    v_mov_b64 v[36:37], 0
    v_mov_b64 v[38:39], 0
    v_mov_b64 v[40:41], 0
    v_mov_b64 v[42:43], 0
    v_mov_b64 v[44:45], 0
    v_mov_b64 v[46:47], 0
    v_mov_b64 v[48:49], 0
    v_mov_b64 v[50:51], 0
    v_mov_b64 v[52:53], 0
    v_mov_b64 v[54:55], 0
    v_mov_b64 v[56:57], 0
    v_mov_b64 v[58:59], 0
    v_mov_b64 v[60:61], 0
    v_mov_b64 v[62:63], 0
    s_mov_b32 s63, 0
L_k:
    s_bitcmp0_b32 s91, 0
    s_waitcnt vmcnt(11)
    s_cbranch_scc1 L_w1
    s_waitcnt vmcnt(10)
L_w1:
    buffer_load_dwordx4 v[140:143], v1, s[4:7], s38 offen offset:1536 nt
    s_bitcmp0_b32 s91, 0
    s_waitcnt vmcnt(11)
    s_cbranch_scc1 L_w2
    s_waitcnt vmcnt(10)
L_w2:
    buffer_load_dwordx4 v[144:147], v1, s[4:7], s38 offen offset:2048 nt
    v_perm_b32 v64, v100, v96, s36
    v_perm_b32 v68, v100, v96, s37
    v_perm_b32 v72, v101, v97, s36
    v_perm_b32 v76, v101, v97, s37
    v_perm_b32 v80, v102, v98, s36
    v_perm_b32 v84, v102, v98, s37
    v_perm_b32 v88, v103, v99, s36
    v_perm_b32 v92, v103, v99, s37
    s_bitcmp0_b32 s91, 0
    s_waitcnt vmcnt(11)
    s_cbranch_scc1 L_w3
    s_waitcnt vmcnt(10)
L_w3:
    buffer_load_dwordx4 v[148:151], v1, s[4:7], s38 offen offset:2560 nt
    s_bitcmp0_b32 s91, 0
    s_waitcnt vmcnt(11)
    s_cbranch_scc1 L_w4
    s_waitcnt vmcnt(10)
L_w4:
    buffer_load_dwordx4 v[28:31], v2, s[12:15], s39 offen
    buffer_load_dwordx4 v[152:155], v1, s[4:7], s38 offen offset:3072 nt
    v_perm_b32 v65, v108, v104, s36
    v_perm_b32 v69, v108, v104, s37
    v_perm_b32 v73, v109, v105, s36
    v_perm_b32 v77, v109, v105, s37
    v_perm_b32 v81, v110, v106, s36
    v_perm_b32 v85, v110, v106, s37
    v_perm_b32 v89, v111, v107, s36
    v_perm_b32 v93, v111, v107, s37
    s_waitcnt vmcnt(12)
    buffer_load_dwordx4 v[156:159], v1, s[4:7], s38 offen offset:3584 nt
    s_add_u32 s73, s73, 0xc000
    s_xor_b32 s38, s73, s72
    s_bfe_u32 s39, s38, 0xe0008
    s_waitcnt vmcnt(12)
    buffer_load_dwordx4 v[96:99], v1, s[4:7], s38 offen offset:0 nt
    v_perm_b32 v66, v116, v112, s36
    v_perm_b32 v70, v116, v112, s37
    v_perm_b32 v74, v117, v113, s36
    v_perm_b32 v78, v117, v113, s37
    v_perm_b32 v82, v118, v114, s36
    v_perm_b32 v86, v118, v114, s37
    v_perm_b32 v90, v119, v115, s36
    v_perm_b32 v94, v119, v115, s37
    s_waitcnt vmcnt(11)
    buffer_load_dwordx4 v[100:103], v1, s[4:7], s38 offen offset:512 nt
    s_waitcnt vmcnt(11)
    buffer_load_dwordx4 v[104:107], v1, s[4:7], s38 offen offset:1024 nt
    v_perm_b32 v67, v124, v120, s36
    v_perm_b32 v71, v124, v120, s37
    v_perm_b32 v75, v125, v121, s36
    v_mfma_f32_16x16x32_bf16 v[32:35], v[24:27], v[64:67], v[32:35]
    v_perm_b32 v79, v125, v121, s37
    v_mfma_f32_16x16x32_bf16 v[36:39], v[24:27], v[68:71], v[36:39]
    v_perm_b32 v83, v126, v122, s36
    v_mfma_f32_16x16x32_bf16 v[40:43], v[24:27], v[72:75], v[40:43]
    v_perm_b32 v87, v126, v122, s37
    v_mfma_f32_16x16x32_bf16 v[44:47], v[24:27], v[76:79], v[44:47]
    v_perm_b32 v91, v127, v123, s36
    v_mfma_f32_16x16x32_bf16 v[48:51], v[24:27], v[80:83], v[48:51]
    v_perm_b32 v95, v127, v123, s37
    v_mfma_f32_16x16x32_bf16 v[52:55], v[24:27], v[84:87], v[52:55]
    v_mfma_f32_16x16x32_bf16 v[56:59], v[24:27], v[88:91], v[56:59]
    v_mfma_f32_16x16x32_bf16 v[60:63], v[24:27], v[92:95], v[60:63]
    s_bitcmp0_b32 s91, 0
    s_waitcnt vmcnt(11)
    s_cbranch_scc1 L_w5
    s_waitcnt vmcnt(10)
L_w5:
    buffer_load_dwordx4 v[108:111], v1, s[4:7], s38 offen offset:1536 nt
    s_bitcmp0_b32 s91, 0
    s_waitcnt vmcnt(11)
    s_cbranch_scc1 L_w6
    s_waitcnt vmcnt(10)
L_w6:
    buffer_load_dwordx4 v[112:115], v1, s[4:7], s38 offen offset:2048 nt
    v_perm_b32 v64, v132, v128, s36
    v_perm_b32 v68, v132, v128, s37
    v_perm_b32 v72, v133, v129, s36
    v_perm_b32 v76, v133, v129, s37
    v_perm_b32 v80, v134, v130, s36
    v_perm_b32 v84, v134, v130, s37
    v_perm_b32 v88, v135, v131, s36
    v_perm_b32 v92, v135, v131, s37
    s_bitcmp0_b32 s91, 0
    s_waitcnt vmcnt(11)
    s_cbranch_scc1 L_w7
    s_waitcnt vmcnt(10)
L_w7:
    buffer_load_dwordx4 v[116:119], v1, s[4:7], s38 offen offset:2560 nt
    s_bitcmp0_b32 s91, 0
    s_waitcnt vmcnt(11)
    s_cbranch_scc1 L_w8
    s_waitcnt vmcnt(10)
L_w8:
    buffer_load_dwordx4 v[24:27], v2, s[12:15], s39 offen
    buffer_load_dwordx4 v[120:123], v1, s[4:7], s38 offen offset:3072 nt
    v_perm_b32 v65, v140, v136, s36
    v_perm_b32 v69, v140, v136, s37
    v_perm_b32 v73, v141, v137, s36
    v_perm_b32 v77, v141, v137, s37
    v_perm_b32 v81, v142, v138, s36
    v_perm_b32 v85, v142, v138, s37
    v_perm_b32 v89, v143, v139, s36
    v_perm_b32 v93, v143, v139, s37
    s_waitcnt vmcnt(12)
    buffer_load_dwordx4 v[124:127], v1, s[4:7], s38 offen offset:3584 nt
    s_add_u32 s73, s73, 0x4000
    s_xor_b32 s38, s73, s72
    s_bfe_u32 s39, s38, 0xe0008
    s_waitcnt vmcnt(12)
    buffer_load_dwordx4 v[128:131], v1, s[4:7], s38 offen offset:0 nt
    v_perm_b32 v66, v148, v144, s36
    v_perm_b32 v70, v148, v144, s37
    v_perm_b32 v74, v149, v145, s36
    v_perm_b32 v78, v149, v145, s37
    v_perm_b32 v82, v150, v146, s36
    v_perm_b32 v86, v150, v146, s37
    v_perm_b32 v90, v151, v147, s36
    v_perm_b32 v94, v151, v147, s37
    s_waitcnt vmcnt(11)
    buffer_load_dwordx4 v[132:135], v1, s[4:7], s38 offen offset:512 nt
    s_waitcnt vmcnt(11)
    buffer_load_dwordx4 v[136:139], v1, s[4:7], s38 offen offset:1024 nt
    v_perm_b32 v67, v156, v152, s36
    v_perm_b32 v71, v156, v152, s37
    v_perm_b32 v75, v157, v153, s36
    v_mfma_f32_16x16x32_bf16 v[32:35], v[28:31], v[64:67], v[32:35]
    v_perm_b32 v79, v157, v153, s37
    v_mfma_f32_16x16x32_bf16 v[36:39], v[28:31], v[68:71], v[36:39]
    v_perm_b32 v83, v158, v154, s36
    v_mfma_f32_16x16x32_bf16 v[40:43], v[28:31], v[72:75], v[40:43]
    v_perm_b32 v87, v158, v154, s37
    v_mfma_f32_16x16x32_bf16 v[44:47], v[28:31], v[76:79], v[44:47]
    v_perm_b32 v91, v159, v155, s36
    v_mfma_f32_16x16x32_bf16 v[48:51], v[28:31], v[80:83], v[48:51]
    v_perm_b32 v95, v159, v155, s37
    v_mfma_f32_16x16x32_bf16 v[52:55], v[28:31], v[84:87], v[52:55]
    v_mfma_f32_16x16x32_bf16 v[56:59], v[28:31], v[88:91], v[56:59]
    v_mfma_f32_16x16x32_bf16 v[60:63], v[28:31], v[92:95], v[60:63]
L_k_back:
    s_add_u32 s63, s63, 1
    s_cmp_le_u32 s63, 14
    s_cbranch_scc1 L_k
    s_bitcmp0_b32 s91, 0
    s_waitcnt vmcnt(11)
    s_cbranch_scc1 L_w9
    s_waitcnt vmcnt(10)
L_w9:
    buffer_load_dwordx4 v[140:143], v1, s[4:7], s38 offen offset:1536 nt
    v_readfirstlane_b32 s3, v6
    s_mov_b64 s[8:9], s[44:45]
    s_mov_b32 s10, 0x8000000
    s_mov_b32 s11, 0x20000
    s_mov_b64 s[20:21], s[40:41]
    s_mov_b32 s22, 0x4000
    s_mov_b32 s23, 0x20000
    s_lshr_b32 s61, s2, 3
    s_lshl_b32 s80, s61, 9
    buffer_load_dwordx4 v[16:19], v10, s[20:23], s80 offen
    s_bitcmp0_b32 s91, 0
    s_waitcnt vmcnt(12)
    s_cbranch_scc1 L_w10
    s_waitcnt vmcnt(11)
L_w10:
    buffer_load_dwordx4 v[144:147], v1, s[4:7], s38 offen offset:2048 nt
    v_perm_b32 v64, v100, v96, s36
    v_perm_b32 v68, v100, v96, s37
    v_perm_b32 v72, v101, v97, s36
    v_perm_b32 v76, v101, v97, s37
    v_perm_b32 v80, v102, v98, s36
    v_perm_b32 v84, v102, v98, s37
    v_perm_b32 v88, v103, v99, s36
    v_perm_b32 v92, v103, v99, s37
    s_mov_b64 s[32:33], s[54:55]
    s_mov_b32 s34, 0x20000000
    s_mov_b32 s35, 0x20000
    s_lshl_b32 s58, s61, 10
    s_add_u32 s58, s58, 0x90000
    v_and_b32 v7, 3, v0
    v_lshlrev_b32 v7, 8, v7
    s_mov_b64 exec, 5
    buffer_load_dword v9, v7, s[32:35], s58 offen sc1
    s_mov_b64 exec, -1
    s_bitcmp0_b32 s91, 0
    s_waitcnt vmcnt(13)
    s_cbranch_scc1 L_w11
    s_waitcnt vmcnt(12)
L_w11:
    buffer_load_dwordx4 v[148:151], v1, s[4:7], s38 offen offset:2560 nt
    s_mov_b64 s[16:17], s[48:49]
    s_mov_b32 s18, 0x40000
    s_mov_b32 s19, 0x20000
    s_lshr_b32 s59, s2, 1
    s_xor_b32 s59, s59, s61
    s_and_b32 s90, s59, 1
    s_lshl_b32 s83, s3, 1
    s_lshl_b32 s59, s83, 8
    s_add_u32 s77, s58, s59
    s_bitcmp0_b32 s91, 0
    s_waitcnt vmcnt(13)
    s_cbranch_scc1 L_w12
    s_waitcnt vmcnt(12)
L_w12:
    buffer_load_dwordx4 v[28:31], v2, s[12:15], s39 offen
    buffer_load_dwordx4 v[152:155], v1, s[4:7], s38 offen offset:3072 nt
    v_perm_b32 v65, v108, v104, s36
    v_perm_b32 v69, v108, v104, s37
    v_perm_b32 v73, v109, v105, s36
    v_perm_b32 v77, v109, v105, s37
    v_perm_b32 v81, v110, v106, s36
    v_perm_b32 v85, v110, v106, s37
    v_perm_b32 v89, v111, v107, s36
    v_perm_b32 v93, v111, v107, s37
    s_waitcnt vmcnt(14)
    buffer_load_dwordx4 v[156:159], v1, s[4:7], s38 offen offset:3584 nt
    s_bfe_u32 s73, s2, 0x20003
    s_lshl_b32 s73, s73, 18
    s_xor_b32 s85, s72, s74
    s_bfe_u32 s84, s2, 0x10005
    s_lshl_b32 s84, s84, 16
    s_or_b32 s85, s85, s84
    s_bfe_u32 s84, s2, 0x10006
    s_lshl_b32 s84, s84, 17
    s_or_b32 s84, s84, s85
    s_cmp_ge_u32 s73, 0xc0000
    s_cselect_b32 s72, s85, s84
    s_xor_b32 s38, s73, s72
    s_bfe_u32 s39, s38, 0xe0008
    s_waitcnt vmcnt(14)
    buffer_load_dwordx4 v[96:99], v1, s[8:11], s38 offen offset:0 nt
    v_perm_b32 v66, v116, v112, s36
    v_perm_b32 v70, v116, v112, s37
    v_perm_b32 v74, v117, v113, s36
    v_perm_b32 v78, v117, v113, s37
    v_perm_b32 v82, v118, v114, s36
    v_perm_b32 v86, v118, v114, s37
    v_perm_b32 v90, v119, v115, s36
    v_perm_b32 v94, v119, v115, s37
    s_waitcnt vmcnt(13)
    buffer_load_dwordx4 v[100:103], v1, s[8:11], s38 offen offset:512 nt
    s_mov_b64 s[24:25], s[50:51]
    s_mov_b32 s26, 0x4000
    s_mov_b32 s27, 0x20000
    s_mov_b32 s31, 0x3db8aa3b
    s_lshl_b32 s78, s61, 22
    s_lshl_b32 s60, s2, 11
    s_lshl_b32 s76, s2, 8
    s_add_u32 s76, s76, 0x80000
    s_lshl_b32 s75, s61, 11
    s_add_u32 s75, s75, 0x80000
    v_lshlrev_b32 v11, 7, v4
    v_lshl_add_u32 v11, v5, 5, v11
    s_waitcnt vmcnt(13)
    buffer_load_dwordx4 v[104:107], v1, s[8:11], s38 offen offset:1024 nt
    v_perm_b32 v67, v124, v120, s36
    v_perm_b32 v71, v124, v120, s37
    v_perm_b32 v75, v125, v121, s36
    v_mfma_f32_16x16x32_bf16 v[32:35], v[24:27], v[64:67], v[32:35]
    v_perm_b32 v79, v125, v121, s37
    v_mfma_f32_16x16x32_bf16 v[36:39], v[24:27], v[68:71], v[36:39]
    v_perm_b32 v83, v126, v122, s36
    v_mfma_f32_16x16x32_bf16 v[40:43], v[24:27], v[72:75], v[40:43]
    v_perm_b32 v87, v126, v122, s37
    v_mfma_f32_16x16x32_bf16 v[44:47], v[24:27], v[76:79], v[44:47]
    v_perm_b32 v91, v127, v123, s36
    v_mfma_f32_16x16x32_bf16 v[48:51], v[24:27], v[80:83], v[48:51]
    v_perm_b32 v95, v127, v123, s37
    v_mfma_f32_16x16x32_bf16 v[52:55], v[24:27], v[84:87], v[52:55]
    v_mfma_f32_16x16x32_bf16 v[56:59], v[24:27], v[88:91], v[56:59]
    v_mfma_f32_16x16x32_bf16 v[60:63], v[24:27], v[92:95], v[60:63]
    s_bitcmp0_b32 s91, 0
    s_waitcnt vmcnt(13)
    s_cbranch_scc1 L_w13
    s_waitcnt vmcnt(12)
L_w13:
    buffer_load_dwordx4 v[108:111], v1, s[8:11], s38 offen offset:1536 nt
    v_lshlrev_b32 v12, 7, v6
    v_lshl_add_u32 v12, v5, 5, v12
    v_lshl_add_u32 v12, v4, 4, v12
    v_lshlrev_b32 v13, 4, v0
    s_bfe_u32 s88, s2, 0x10002
    s_lshl_b32 s88, s88, 1
    s_and_b32 s59, s2, 1
    s_or_b32 s88, s88, s59
    v_lshlrev_b32 v3, 3, v4
    v_lshl_add_u32 v3, v5, 12, v3
    s_lshl_b32 s59, s88, 7
    v_add_u32 v3, s59, v3
    s_bitcmp0_b32 s91, 0
    s_waitcnt vmcnt(13)
    s_cbranch_scc1 L_w14
    s_waitcnt vmcnt(12)
L_w14:
    buffer_load_dwordx4 v[112:115], v1, s[8:11], s38 offen offset:2048 nt
    v_perm_b32 v64, v132, v128, s36
    v_perm_b32 v68, v132, v128, s37
    v_perm_b32 v72, v133, v129, s36
    v_perm_b32 v76, v133, v129, s37
    v_perm_b32 v80, v134, v130, s36
    v_perm_b32 v84, v134, v130, s37
    v_perm_b32 v88, v135, v131, s36
    v_perm_b32 v92, v135, v131, s37
    s_bitcmp0_b32 s91, 0
    s_waitcnt vmcnt(13)
    s_cbranch_scc1 L_w15
    s_waitcnt vmcnt(12)
L_w15:
    buffer_load_dwordx4 v[116:119], v1, s[8:11], s38 offen offset:2560 nt
    v_and_b32 v7, 1, v4
    v_lshl_add_u32 v7, v7, 2, v5
    v_lshrrev_b32 v8, 1, v7
    v_lshlrev_b32 v14, 8, v8
    v_and_b32 v7, 1, v7
    v_lshl_add_u32 v14, v7, 3, v14
    v_lshrrev_b32 v8, 1, v4
    v_lshl_add_u32 v14, v8, 4, v14
    s_lshl_b32 s81, s61, 14
    s_lshl_b32 s59, s3, 13
    s_add_u32 s81, s81, s59
    s_lshr_b32 s59, s88, 1
    s_lshl_b32 s59, s59, 10
    s_add_u32 s81, s81, s59
    s_and_b32 s59, s88, 1
    s_lshl_b32 s59, s59, 7
    s_add_u32 s81, s81, s59
    s_add_u32 s82, s81, 0x1000
    s_bitcmp0_b32 s91, 0
    s_waitcnt vmcnt(13)
    s_cbranch_scc1 L_w16
    s_waitcnt vmcnt(11)
L_w16:
    buffer_load_dwordx4 v[24:27], v2, s[16:19], s39 offen
    buffer_load_dwordx4 v[120:123], v1, s[8:11], s38 offen offset:3072 nt
    v_perm_b32 v65, v140, v136, s36
    v_perm_b32 v69, v140, v136, s37
    v_perm_b32 v73, v141, v137, s36
    v_perm_b32 v77, v141, v137, s37
    v_perm_b32 v81, v142, v138, s36
    v_perm_b32 v85, v142, v138, s37
    v_perm_b32 v89, v143, v139, s36
    v_perm_b32 v93, v143, v139, s37
    s_waitcnt vmcnt(13)
    buffer_load_dwordx4 v[124:127], v1, s[8:11], s38 offen offset:3584 nt
    s_add_u32 s73, s73, 0x4000
    s_xor_b32 s38, s73, s72
    s_bfe_u32 s39, s38, 0xe0008
    s_waitcnt vmcnt(12)
    buffer_load_dwordx4 v[128:131], v1, s[8:11], s38 offen offset:0 nt
    v_perm_b32 v66, v148, v144, s36
    v_perm_b32 v70, v148, v144, s37
    v_perm_b32 v74, v149, v145, s36
    v_perm_b32 v78, v149, v145, s37
    v_perm_b32 v82, v150, v146, s36
    v_perm_b32 v86, v150, v146, s37
    v_perm_b32 v90, v151, v147, s36
    v_perm_b32 v94, v151, v147, s37
    s_waitcnt vmcnt(11)
    buffer_load_dwordx4 v[132:135], v1, s[8:11], s38 offen offset:512 nt
    v_lshlrev_b32 v15, 3, v4
    v_lshl_add_u32 v15, v5, 1, v15
    s_lshl_b32 s59, s88, 7
    s_add_u32 s80, s80, s59
    s_waitcnt vmcnt(11)
    buffer_load_dwordx4 v[136:139], v1, s[8:11], s38 offen offset:1024 nt
    v_perm_b32 v67, v156, v152, s36
    v_perm_b32 v71, v156, v152, s37
    v_perm_b32 v75, v157, v153, s36
    v_mfma_f32_16x16x32_bf16 v[32:35], v[28:31], v[64:67], v[32:35]
    v_perm_b32 v79, v157, v153, s37
    v_mfma_f32_16x16x32_bf16 v[36:39], v[28:31], v[68:71], v[36:39]
    v_perm_b32 v83, v158, v154, s36
    v_mfma_f32_16x16x32_bf16 v[40:43], v[28:31], v[72:75], v[40:43]
    v_perm_b32 v87, v158, v154, s37
    v_mfma_f32_16x16x32_bf16 v[44:47], v[28:31], v[76:79], v[44:47]
    v_perm_b32 v91, v159, v155, s36
    v_mfma_f32_16x16x32_bf16 v[48:51], v[28:31], v[80:83], v[48:51]
    v_perm_b32 v95, v159, v155, s37
    v_mfma_f32_16x16x32_bf16 v[52:55], v[28:31], v[84:87], v[52:55]
    v_mfma_f32_16x16x32_bf16 v[56:59], v[28:31], v[88:91], v[56:59]
    v_mfma_f32_16x16x32_bf16 v[60:63], v[28:31], v[92:95], v[60:63]
    s_bitcmp0_b32 s91, 0
    s_waitcnt vmcnt(11)
    s_cbranch_scc1 L_w17
    s_waitcnt vmcnt(10)
L_w17:
    buffer_load_dwordx4 v[140:143], v1, s[8:11], s38 offen offset:1536 nt
    v_lshlrev_b32 v4, 16, v16
    v_mul_f32 v20, v4, v32
    v_mul_f32 v21, v4, v33
    v_mul_f32 v22, v4, v34
    v_mul_f32 v23, v4, v35
    v_and_b32 v4, 0xffff0000, v16
    v_fmac_f32 v20, v4, v36
    v_fmac_f32 v21, v4, v37
    v_fmac_f32 v22, v4, v38
    v_fmac_f32 v23, v4, v39
    v_lshlrev_b32 v4, 16, v17
    v_fmac_f32 v20, v4, v40
    v_fmac_f32 v21, v4, v41
    v_fmac_f32 v22, v4, v42
    v_fmac_f32 v23, v4, v43
    s_bitcmp0_b32 s91, 0
    s_waitcnt vmcnt(11)
    s_cbranch_scc1 L_w18
    s_waitcnt vmcnt(10)
L_w18:
    buffer_load_dwordx4 v[144:147], v1, s[8:11], s38 offen offset:2048 nt
    v_perm_b32 v64, v100, v96, s36
    v_perm_b32 v68, v100, v96, s37
    v_perm_b32 v72, v101, v97, s36
    v_perm_b32 v76, v101, v97, s37
    v_perm_b32 v80, v102, v98, s36
    v_perm_b32 v84, v102, v98, s37
    v_perm_b32 v88, v103, v99, s36
    v_perm_b32 v92, v103, v99, s37
    s_bitcmp0_b32 s91, 0
    s_waitcnt vmcnt(11)
    s_cbranch_scc1 L_w19
    s_waitcnt vmcnt(10)
L_w19:
    buffer_load_dwordx4 v[148:151], v1, s[8:11], s38 offen offset:2560 nt
    v_and_b32 v4, 0xffff0000, v17
    v_fmac_f32 v20, v4, v44
    v_fmac_f32 v21, v4, v45
    v_fmac_f32 v22, v4, v46
    v_fmac_f32 v23, v4, v47
    v_lshlrev_b32 v4, 16, v18
    v_fmac_f32 v20, v4, v48
    v_fmac_f32 v21, v4, v49
    v_fmac_f32 v22, v4, v50
    v_fmac_f32 v23, v4, v51
    s_bitcmp0_b32 s91, 0
    s_waitcnt vmcnt(11)
    s_cbranch_scc1 L_w20
    s_waitcnt vmcnt(10)
L_w20:
    buffer_load_dwordx4 v[28:31], v2, s[16:19], s39 offen
    buffer_load_dwordx4 v[152:155], v1, s[8:11], s38 offen offset:3072 nt
    v_perm_b32 v65, v108, v104, s36
    v_perm_b32 v69, v108, v104, s37
    v_perm_b32 v73, v109, v105, s36
    v_perm_b32 v77, v109, v105, s37
    v_perm_b32 v81, v110, v106, s36
    v_perm_b32 v85, v110, v106, s37
    v_perm_b32 v89, v111, v107, s36
    v_perm_b32 v93, v111, v107, s37
    s_waitcnt vmcnt(12)
    buffer_load_dwordx4 v[156:159], v1, s[8:11], s38 offen offset:3584 nt
    s_add_u32 s73, s73, 0xc000
    s_cmp_eq_u32 s73, 0xe0000
    s_cselect_b32 s73, 0, s73
    s_cmp_ge_u32 s73, 0xc0000
    s_cselect_b32 s72, s85, s84
    s_xor_b32 s38, s73, s72
    s_bfe_u32 s39, s38, 0xe0008
    v_and_b32 v4, 0xffff0000, v18
    v_fmac_f32 v20, v4, v52
    v_fmac_f32 v21, v4, v53
    v_fmac_f32 v22, v4, v54
    v_fmac_f32 v23, v4, v55
    v_lshlrev_b32 v4, 16, v19
    v_fmac_f32 v20, v4, v56
    v_fmac_f32 v21, v4, v57
    v_fmac_f32 v22, v4, v58
    v_fmac_f32 v23, v4, v59
    s_waitcnt vmcnt(12)
    buffer_load_dwordx4 v[96:99], v1, s[8:11], s38 offen offset:0 nt
    v_perm_b32 v66, v116, v112, s36
    v_perm_b32 v70, v116, v112, s37
    v_perm_b32 v74, v117, v113, s36
    v_perm_b32 v78, v117, v113, s37
    v_perm_b32 v82, v118, v114, s36
    v_perm_b32 v86, v118, v114, s37
    v_perm_b32 v90, v119, v115, s36
    v_perm_b32 v94, v119, v115, s37
    s_waitcnt vmcnt(11)
    buffer_load_dwordx4 v[100:103], v1, s[8:11], s38 offen offset:512 nt
    v_and_b32 v4, 0xffff0000, v19
    v_fmac_f32 v20, v4, v60
    v_fmac_f32 v21, v4, v61
    v_fmac_f32 v22, v4, v62
    v_fmac_f32 v23, v4, v63
    v_readlane_b32 s28, v9, 0
    v_readlane_b32 s29, v9, s83
    s_waitcnt vmcnt(11)
    buffer_load_dwordx4 v[104:107], v1, s[8:11], s38 offen offset:1024 nt
    v_perm_b32 v67, v124, v120, s36
    v_perm_b32 v71, v124, v120, s37
    v_perm_b32 v75, v125, v121, s36
    v_mfma_f32_16x16x32_bf16 v[32:35], v[24:27], v[64:67], 0
    v_perm_b32 v79, v125, v121, s37
    v_mfma_f32_16x16x32_bf16 v[36:39], v[24:27], v[68:71], 0
    v_perm_b32 v83, v126, v122, s36
    v_mfma_f32_16x16x32_bf16 v[40:43], v[24:27], v[72:75], 0
    v_perm_b32 v87, v126, v122, s37
    v_mfma_f32_16x16x32_bf16 v[44:47], v[24:27], v[76:79], 0
    v_perm_b32 v91, v127, v123, s36
    v_mfma_f32_16x16x32_bf16 v[48:51], v[24:27], v[80:83], 0
    v_perm_b32 v95, v127, v123, s37
    v_mfma_f32_16x16x32_bf16 v[52:55], v[24:27], v[84:87], 0
    v_mfma_f32_16x16x32_bf16 v[56:59], v[24:27], v[88:91], 0
    v_mfma_f32_16x16x32_bf16 v[60:63], v[24:27], v[92:95], 0
    s_bitcmp0_b32 s91, 0
    s_waitcnt vmcnt(11)
    s_cbranch_scc1 L_w21
    s_waitcnt vmcnt(10)
L_w21:
    buffer_load_dwordx4 v[108:111], v1, s[8:11], s38 offen offset:1536 nt
    s_xor_b32 s28, s28, 0x5bd1e995
    v_add_f32_dpp v20, v20, v20 row_ror:8 row_mask:0xf bank_mask:0xf
    v_add_f32_dpp v21, v21, v21 row_ror:8 row_mask:0xf bank_mask:0xf
    v_add_f32_dpp v22, v22, v22 row_ror:8 row_mask:0xf bank_mask:0xf
    v_add_f32_dpp v23, v23, v23 row_ror:8 row_mask:0xf bank_mask:0xf
    v_add_f32_dpp v20, v20, v20 row_ror:4 row_mask:0xf bank_mask:0xf
    v_add_f32_dpp v21, v21, v21 row_ror:4 row_mask:0xf bank_mask:0xf
    v_add_f32_dpp v22, v22, v22 row_ror:4 row_mask:0xf bank_mask:0xf
    v_add_f32_dpp v23, v23, v23 row_ror:4 row_mask:0xf bank_mask:0xf
    s_bitcmp0_b32 s91, 0
    s_waitcnt vmcnt(11)
    s_cbranch_scc1 L_w22
    s_waitcnt vmcnt(10)
L_w22:
    buffer_load_dwordx4 v[112:115], v1, s[8:11], s38 offen offset:2048 nt
    v_perm_b32 v64, v132, v128, s36
    v_perm_b32 v68, v132, v128, s37
    v_perm_b32 v72, v133, v129, s36
    v_perm_b32 v76, v133, v129, s37
    v_perm_b32 v80, v134, v130, s36
    v_perm_b32 v84, v134, v130, s37
    v_perm_b32 v88, v135, v131, s36
    v_perm_b32 v92, v135, v131, s37
    s_bitcmp0_b32 s91, 0
    s_waitcnt vmcnt(11)
    s_cbranch_scc1 L_w23
    s_waitcnt vmcnt(10)
L_w23:
    buffer_load_dwordx4 v[116:119], v1, s[8:11], s38 offen offset:2560 nt
    v_add_f32_dpp v20, v20, v20 row_ror:2 row_mask:0xf bank_mask:0xf
    v_add_f32_dpp v21, v21, v21 row_ror:2 row_mask:0xf bank_mask:0xf
    v_add_f32_dpp v22, v22, v22 row_ror:2 row_mask:0xf bank_mask:0xf
    v_add_f32_dpp v23, v23, v23 row_ror:2 row_mask:0xf bank_mask:0xf
    v_add_f32_dpp v20, v20, v20 row_ror:1 row_mask:0xf bank_mask:0xf
    v_add_f32_dpp v21, v21, v21 row_ror:1 row_mask:0xf bank_mask:0xf
    v_add_f32_dpp v22, v22, v22 row_ror:1 row_mask:0xf bank_mask:0xf
    v_add_f32_dpp v23, v23, v23 row_ror:1 row_mask:0xf bank_mask:0xf
    s_mov_b32 vcc_lo, 0x00020002
    s_mov_b32 vcc_hi, 0x00020002
    v_cndmask_b32 v160, v20, v22, vcc
    v_mov_b32 v161, s28
    v_cndmask_b32 v162, v21, v23, vcc
    v_mov_b32 v163, s28
    s_bitcmp0_b32 s91, 0
    s_waitcnt vmcnt(11)
    s_cbranch_scc1 L_w24
    s_waitcnt vmcnt(10)
L_w24:
    buffer_load_dwordx4 v[24:27], v2, s[16:19], s39 offen
    buffer_load_dwordx4 v[120:123], v1, s[8:11], s38 offen offset:3072 nt
    v_perm_b32 v65, v140, v136, s36
    v_perm_b32 v69, v140, v136, s37
    v_perm_b32 v73, v141, v137, s36
    v_perm_b32 v77, v141, v137, s37
    v_perm_b32 v81, v142, v138, s36
    v_perm_b32 v85, v142, v138, s37
    v_perm_b32 v89, v143, v139, s36
    v_perm_b32 v93, v143, v139, s37
    s_waitcnt vmcnt(12)
    buffer_load_dwordx4 v[124:127], v1, s[8:11], s38 offen offset:3584 nt
    s_add_u32 s73, s73, 0x4000
    s_xor_b32 s38, s73, s72
    s_bfe_u32 s39, s38, 0xe0008
    s_waitcnt vmcnt(12)
    buffer_load_dwordx4 v[128:131], v1, s[8:11], s38 offen offset:0 nt
    v_perm_b32 v66, v148, v144, s36
    v_perm_b32 v70, v148, v144, s37
    v_perm_b32 v74, v149, v145, s36
    v_perm_b32 v78, v149, v145, s37
    v_perm_b32 v82, v150, v146, s36
    v_perm_b32 v86, v150, v146, s37
    v_perm_b32 v90, v151, v147, s36
    v_perm_b32 v94, v151, v147, s37
    s_waitcnt vmcnt(11)
    buffer_load_dwordx4 v[132:135], v1, s[8:11], s38 offen offset:512 nt
    s_mov_b32 exec_lo, 0x00030003
    s_mov_b32 exec_hi, 0x00030003
    buffer_store_dwordx4 v[160:163], v12, s[32:35], s76 offen sc1
    s_mov_b64 exec, -1
    s_waitcnt vmcnt(11)
    buffer_load_dwordx4 v[136:139], v1, s[8:11], s38 offen offset:1024 nt
    v_perm_b32 v67, v156, v152, s36
    v_perm_b32 v71, v156, v152, s37
    v_perm_b32 v75, v157, v153, s36
    v_mfma_f32_16x16x32_bf16 v[32:35], v[28:31], v[64:67], v[32:35]
    v_perm_b32 v79, v157, v153, s37
    v_mfma_f32_16x16x32_bf16 v[36:39], v[28:31], v[68:71], v[36:39]
    v_perm_b32 v83, v158, v154, s36
    v_mfma_f32_16x16x32_bf16 v[40:43], v[28:31], v[72:75], v[40:43]
    v_perm_b32 v87, v158, v154, s37
    v_mfma_f32_16x16x32_bf16 v[44:47], v[28:31], v[76:79], v[44:47]
    v_perm_b32 v91, v159, v155, s36
    v_mfma_f32_16x16x32_bf16 v[48:51], v[28:31], v[80:83], v[48:51]
    v_perm_b32 v95, v159, v155, s37
    v_mfma_f32_16x16x32_bf16 v[52:55], v[28:31], v[84:87], v[52:55]
    v_mfma_f32_16x16x32_bf16 v[56:59], v[28:31], v[88:91], v[56:59]
    v_mfma_f32_16x16x32_bf16 v[60:63], v[28:31], v[92:95], v[60:63]
    s_mov_b32 s63, 17
L_v:
    s_bitcmp0_b32 s91, 0
    s_waitcnt vmcnt(11)
    s_cbranch_scc1 L_w25
    s_waitcnt vmcnt(10)
L_w25:
    buffer_load_dwordx4 v[140:143], v1, s[8:11], s38 offen offset:1536 nt
    s_bitcmp0_b32 s91, 0
    s_waitcnt vmcnt(11)
    s_cbranch_scc1 L_w26
    s_waitcnt vmcnt(10)
L_w26:
    buffer_load_dwordx4 v[144:147], v1, s[8:11], s38 offen offset:2048 nt
    v_perm_b32 v64, v100, v96, s36
    v_perm_b32 v68, v100, v96, s37
    v_perm_b32 v72, v101, v97, s36
    v_perm_b32 v76, v101, v97, s37
    v_perm_b32 v80, v102, v98, s36
    v_perm_b32 v84, v102, v98, s37
    v_perm_b32 v88, v103, v99, s36
    v_perm_b32 v92, v103, v99, s37
    s_bitcmp0_b32 s91, 0
    s_waitcnt vmcnt(11)
    s_cbranch_scc1 L_w27
    s_waitcnt vmcnt(10)
L_w27:
    buffer_load_dwordx4 v[148:151], v1, s[8:11], s38 offen offset:2560 nt
    s_bitcmp0_b32 s91, 0
    s_waitcnt vmcnt(11)
    s_cbranch_scc1 L_w28
    s_waitcnt vmcnt(10)
L_w28:
    buffer_load_dwordx4 v[28:31], v2, s[16:19], s39 offen
    buffer_load_dwordx4 v[152:155], v1, s[8:11], s38 offen offset:3072 nt
    v_perm_b32 v65, v108, v104, s36
    v_perm_b32 v69, v108, v104, s37
    v_perm_b32 v73, v109, v105, s36
    v_perm_b32 v77, v109, v105, s37
    v_perm_b32 v81, v110, v106, s36
    v_perm_b32 v85, v110, v106, s37
    v_perm_b32 v89, v111, v107, s36
    v_perm_b32 v93, v111, v107, s37
    s_waitcnt vmcnt(12)
    buffer_load_dwordx4 v[156:159], v1, s[8:11], s38 offen offset:3584 nt
    s_add_u32 s73, s73, 0xc000
    s_cmp_eq_u32 s73, 0xe0000
    s_cselect_b32 s73, 0, s73
    s_cmp_ge_u32 s73, 0xc0000
    s_cselect_b32 s72, s85, s84
    s_xor_b32 s38, s73, s72
    s_bfe_u32 s39, s38, 0xe0008
    s_waitcnt vmcnt(12)
    buffer_load_dwordx4 v[96:99], v1, s[8:11], s38 offen offset:0 nt
    v_perm_b32 v66, v116, v112, s36
    v_perm_b32 v70, v116, v112, s37
    v_perm_b32 v74, v117, v113, s36
    v_perm_b32 v78, v117, v113, s37
    v_perm_b32 v82, v118, v114, s36
    v_perm_b32 v86, v118, v114, s37
    v_perm_b32 v90, v119, v115, s36
    v_perm_b32 v94, v119, v115, s37
    s_waitcnt vmcnt(11)
    buffer_load_dwordx4 v[100:103], v1, s[8:11], s38 offen offset:512 nt
    s_waitcnt vmcnt(11)
    buffer_load_dwordx4 v[104:107], v1, s[8:11], s38 offen offset:1024 nt
    v_perm_b32 v67, v124, v120, s36
    v_perm_b32 v71, v124, v120, s37
    v_perm_b32 v75, v125, v121, s36
    v_mfma_f32_16x16x32_bf16 v[32:35], v[24:27], v[64:67], v[32:35]
    v_perm_b32 v79, v125, v121, s37
    v_mfma_f32_16x16x32_bf16 v[36:39], v[24:27], v[68:71], v[36:39]
    v_perm_b32 v83, v126, v122, s36
    v_mfma_f32_16x16x32_bf16 v[40:43], v[24:27], v[72:75], v[40:43]
    v_perm_b32 v87, v126, v122, s37
    v_mfma_f32_16x16x32_bf16 v[44:47], v[24:27], v[76:79], v[44:47]
    v_perm_b32 v91, v127, v123, s36
    v_mfma_f32_16x16x32_bf16 v[48:51], v[24:27], v[80:83], v[48:51]
    v_perm_b32 v95, v127, v123, s37
    v_mfma_f32_16x16x32_bf16 v[52:55], v[24:27], v[84:87], v[52:55]
    v_mfma_f32_16x16x32_bf16 v[56:59], v[24:27], v[88:91], v[56:59]
    v_mfma_f32_16x16x32_bf16 v[60:63], v[24:27], v[92:95], v[60:63]
    s_bitcmp0_b32 s91, 0
    s_waitcnt vmcnt(11)
    s_cbranch_scc1 L_w29
    s_waitcnt vmcnt(10)
L_w29:
    buffer_load_dwordx4 v[108:111], v1, s[8:11], s38 offen offset:1536 nt
    s_bitcmp0_b32 s91, 0
    s_waitcnt vmcnt(11)
    s_cbranch_scc1 L_w30
    s_waitcnt vmcnt(10)
L_w30:
    buffer_load_dwordx4 v[112:115], v1, s[8:11], s38 offen offset:2048 nt
    v_perm_b32 v64, v132, v128, s36
    v_perm_b32 v68, v132, v128, s37
    v_perm_b32 v72, v133, v129, s36
    v_perm_b32 v76, v133, v129, s37
    v_perm_b32 v80, v134, v130, s36
    v_perm_b32 v84, v134, v130, s37
    v_perm_b32 v88, v135, v131, s36
    v_perm_b32 v92, v135, v131, s37
    s_bitcmp0_b32 s91, 0
    s_waitcnt vmcnt(11)
    s_cbranch_scc1 L_w31
    s_waitcnt vmcnt(10)
L_w31:
    buffer_load_dwordx4 v[116:119], v1, s[8:11], s38 offen offset:2560 nt
    s_bitcmp0_b32 s91, 0
    s_waitcnt vmcnt(11)
    s_cbranch_scc1 L_w32
    s_waitcnt vmcnt(10)
L_w32:
    buffer_load_dwordx4 v[24:27], v2, s[16:19], s39 offen
    buffer_load_dwordx4 v[120:123], v1, s[8:11], s38 offen offset:3072 nt
    v_perm_b32 v65, v140, v136, s36
    v_perm_b32 v69, v140, v136, s37
    v_perm_b32 v73, v141, v137, s36
    v_perm_b32 v77, v141, v137, s37
    v_perm_b32 v81, v142, v138, s36
    v_perm_b32 v85, v142, v138, s37
    v_perm_b32 v89, v143, v139, s36
    v_perm_b32 v93, v143, v139, s37
    s_waitcnt vmcnt(12)
    buffer_load_dwordx4 v[124:127], v1, s[8:11], s38 offen offset:3584 nt
    s_add_u32 s73, s73, 0x4000
    s_xor_b32 s38, s73, s72
    s_bfe_u32 s39, s38, 0xe0008
    s_waitcnt vmcnt(12)
    buffer_load_dwordx4 v[128:131], v1, s[8:11], s38 offen offset:0 nt
    v_perm_b32 v66, v148, v144, s36
    v_perm_b32 v70, v148, v144, s37
    v_perm_b32 v74, v149, v145, s36
    v_perm_b32 v78, v149, v145, s37
    v_perm_b32 v82, v150, v146, s36
    v_perm_b32 v86, v150, v146, s37
    v_perm_b32 v90, v151, v147, s36
    v_perm_b32 v94, v151, v147, s37
    s_waitcnt vmcnt(11)
    buffer_load_dwordx4 v[132:135], v1, s[8:11], s38 offen offset:512 nt
    s_waitcnt vmcnt(11)
    buffer_load_dwordx4 v[136:139], v1, s[8:11], s38 offen offset:1024 nt
    v_perm_b32 v67, v156, v152, s36
    v_perm_b32 v71, v156, v152, s37
    v_perm_b32 v75, v157, v153, s36
    v_mfma_f32_16x16x32_bf16 v[32:35], v[28:31], v[64:67], v[32:35]
    v_perm_b32 v79, v157, v153, s37
    v_mfma_f32_16x16x32_bf16 v[36:39], v[28:31], v[68:71], v[36:39]
    v_perm_b32 v83, v158, v154, s36
    v_mfma_f32_16x16x32_bf16 v[40:43], v[28:31], v[72:75], v[40:43]
    v_perm_b32 v87, v158, v154, s37
    v_mfma_f32_16x16x32_bf16 v[44:47], v[28:31], v[76:79], v[44:47]
    v_perm_b32 v91, v159, v155, s36
    v_mfma_f32_16x16x32_bf16 v[48:51], v[28:31], v[80:83], v[48:51]
    v_perm_b32 v95, v159, v155, s37
    v_mfma_f32_16x16x32_bf16 v[52:55], v[28:31], v[84:87], v[52:55]
    v_mfma_f32_16x16x32_bf16 v[56:59], v[28:31], v[88:91], v[56:59]
    v_mfma_f32_16x16x32_bf16 v[60:63], v[28:31], v[92:95], v[60:63]
    s_cmp_eq_u32 s63, 25
    s_cbranch_scc1 L_evQ
L_v_back:
    s_add_u32 s63, s63, 1
    s_cmp_le_u32 s63, 27
    s_cbranch_scc1 L_v
L_chkQ:
    v_xor_b32 v4, s28, v165
    v_xor_b32 v5, s28, v167
    v_bitop3_b32 v4, v4, v169, s28 bitop3:0xf6
    v_bitop3_b32 v5, v5, v171, s28 bitop3:0xf6
    v_or_b32 v4, v4, v5
    v_cmp_ne_u32 vcc, 0, v4
    s_cbranch_vccnz L_retryQ
L_okQ:
    s_bitcmp0_b32 s91, 0
    s_waitcnt vmcnt(11)
    s_cbranch_scc1 L_w33
    s_waitcnt vmcnt(10)
L_w33:
    buffer_load_dwordx4 v[140:143], v1, s[8:11], s38 offen offset:1536 nt
    v_add_f32_dpp v20, v164, v164 row_ror:8 row_mask:0xf bank_mask:0xf
    v_add_f32_dpp v21, v166, v166 row_ror:8 row_mask:0xf bank_mask:0xf
    v_add_f32_dpp v22, v168, v168 row_ror:8 row_mask:0xf bank_mask:0xf
    v_add_f32_dpp v23, v170, v170 row_ror:8 row_mask:0xf bank_mask:0xf
    v_add_f32_dpp v20, v20, v20 row_ror:4 row_mask:0xf bank_mask:0xf
    v_add_f32_dpp v21, v21, v21 row_ror:4 row_mask:0xf bank_mask:0xf
    v_add_f32_dpp v22, v22, v22 row_ror:4 row_mask:0xf bank_mask:0xf
    v_add_f32_dpp v23, v23, v23 row_ror:4 row_mask:0xf bank_mask:0xf
    s_bitcmp0_b32 s91, 0
    s_waitcnt vmcnt(11)
    s_cbranch_scc1 L_w34
    s_waitcnt vmcnt(10)
L_w34:
    buffer_load_dwordx4 v[144:147], v1, s[8:11], s38 offen offset:2048 nt
    v_perm_b32 v64, v100, v96, s36
    v_perm_b32 v68, v100, v96, s37
    v_perm_b32 v72, v101, v97, s36
    v_perm_b32 v76, v101, v97, s37
    v_perm_b32 v80, v102, v98, s36
    v_perm_b32 v84, v102, v98, s37
    v_perm_b32 v88, v103, v99, s36
    v_perm_b32 v92, v103, v99, s37
    s_bitcmp0_b32 s91, 0
    s_waitcnt vmcnt(11)
    s_cbranch_scc1 L_w35
    s_waitcnt vmcnt(10)
L_w35:
    buffer_load_dwordx4 v[148:151], v1, s[8:11], s38 offen offset:2560 nt
    v_add_f32_dpp v20, v20, v20 row_ror:2 row_mask:0xf bank_mask:0xf
    v_add_f32_dpp v21, v21, v21 row_ror:2 row_mask:0xf bank_mask:0xf
    v_add_f32_dpp v22, v22, v22 row_ror:2 row_mask:0xf bank_mask:0xf
    v_add_f32_dpp v23, v23, v23 row_ror:2 row_mask:0xf bank_mask:0xf
    v_add_f32_dpp v20, v20, v20 row_ror:1 row_mask:0xf bank_mask:0xf
    v_add_f32_dpp v21, v21, v21 row_ror:1 row_mask:0xf bank_mask:0xf
    v_add_f32_dpp v22, v22, v22 row_ror:1 row_mask:0xf bank_mask:0xf
    v_add_f32_dpp v23, v23, v23 row_ror:1 row_mask:0xf bank_mask:0xf
    s_bitcmp0_b32 s91, 0
    s_waitcnt vmcnt(11)
    s_cbranch_scc1 L_w36
    s_waitcnt vmcnt(10)
L_w36:
    buffer_load_dwordx4 v[28:31], v2, s[16:19], s39 offen
    buffer_load_dwordx4 v[152:155], v1, s[8:11], s38 offen offset:3072 nt
    v_perm_b32 v65, v108, v104, s36
    v_perm_b32 v69, v108, v104, s37
    v_perm_b32 v73, v109, v105, s36
    v_perm_b32 v77, v109, v105, s37
    v_perm_b32 v81, v110, v106, s36
    v_perm_b32 v85, v110, v106, s37
    v_perm_b32 v89, v111, v107, s36
    v_perm_b32 v93, v111, v107, s37
    s_waitcnt vmcnt(12)
    buffer_load_dwordx4 v[156:159], v1, s[8:11], s38 offen offset:3584 nt
    s_add_u32 s73, s73, 0xc000
    s_cmp_eq_u32 s73, 0xe0000
    s_cselect_b32 s73, 0, s73
    s_cmp_ge_u32 s73, 0xc0000
    s_cselect_b32 s72, s85, s84
    s_xor_b32 s38, s73, s72
    s_bfe_u32 s39, s38, 0xe0008
    s_mov_b64 exec, 1
    v_mov_b32 v16, 1
    buffer_atomic_add v16, off, s[32:35], s77 sc0
    s_mov_b64 exec, -1
    v_max3_f32 v4, v20, v21, v22
    v_max_f32 v4, v4, v23
    v_mov_b32 v5, v4
    s_nop 1
    v_permlane32_swap_b32 v4, v5
    v_max_f32 v4, v4, v5
    s_waitcnt vmcnt(13)
    buffer_load_dwordx4 v[96:99], v1, s[8:11], s38 offen offset:0 nt
    v_perm_b32 v66, v116, v112, s36
    v_perm_b32 v70, v116, v112, s37
    v_perm_b32 v74, v117, v113, s36
    v_perm_b32 v78, v117, v113, s37
    v_perm_b32 v82, v118, v114, s36
    v_perm_b32 v86, v118, v114, s37
    v_perm_b32 v90, v119, v115, s36
    v_perm_b32 v94, v119, v115, s37
    s_waitcnt vmcnt(12)
    buffer_load_dwordx4 v[100:103], v1, s[8:11], s38 offen offset:512 nt
    v_mov_b32 v5, v4
    s_nop 1
    v_permlane16_swap_b32 v4, v5
    v_max_f32 v4, v4, v5
    v_sub_f32 v20, v20, v4
    v_sub_f32 v21, v21, v4
    v_sub_f32 v22, v22, v4
    v_sub_f32 v23, v23, v4
    s_waitcnt vmcnt(12)
    buffer_load_dwordx4 v[104:107], v1, s[8:11], s38 offen offset:1024 nt
    v_perm_b32 v67, v124, v120, s36
    v_perm_b32 v71, v124, v120, s37
    v_perm_b32 v75, v125, v121, s36
    v_mfma_f32_16x16x32_bf16 v[32:35], v[24:27], v[64:67], v[32:35]
    v_perm_b32 v79, v125, v121, s37
    v_mfma_f32_16x16x32_bf16 v[36:39], v[24:27], v[68:71], v[36:39]
    v_perm_b32 v83, v126, v122, s36
    v_mfma_f32_16x16x32_bf16 v[40:43], v[24:27], v[72:75], v[40:43]
    v_perm_b32 v87, v126, v122, s37
    v_mfma_f32_16x16x32_bf16 v[44:47], v[24:27], v[76:79], v[44:47]
    v_perm_b32 v91, v127, v123, s36
    v_mfma_f32_16x16x32_bf16 v[48:51], v[24:27], v[80:83], v[48:51]
    v_perm_b32 v95, v127, v123, s37
    v_mfma_f32_16x16x32_bf16 v[52:55], v[24:27], v[84:87], v[52:55]
    v_mfma_f32_16x16x32_bf16 v[56:59], v[24:27], v[88:91], v[56:59]
    v_mfma_f32_16x16x32_bf16 v[60:63], v[24:27], v[92:95], v[60:63]
    s_waitcnt vmcnt(12)
    buffer_load_dwordx4 v[108:111], v1, s[8:11], s38 offen offset:1536 nt
    v_mul_f32 v20, s31, v20
    v_mul_f32 v21, s31, v21
    v_mul_f32 v22, s31, v22
    v_mul_f32 v23, s31, v23
    v_exp_f32 v20, v20
    v_exp_f32 v21, v21
    v_exp_f32 v22, v22
    v_exp_f32 v23, v23
    s_nop 0
    s_waitcnt vmcnt(12)
    buffer_load_dwordx4 v[112:115], v1, s[8:11], s38 offen offset:2048 nt
    v_perm_b32 v64, v132, v128, s36
    v_perm_b32 v68, v132, v128, s37
    v_perm_b32 v72, v133, v129, s36
    v_perm_b32 v76, v133, v129, s37
    v_perm_b32 v80, v134, v130, s36
    v_perm_b32 v84, v134, v130, s37
    v_perm_b32 v88, v135, v131, s36
    v_perm_b32 v92, v135, v131, s37
    s_waitcnt vmcnt(12)
    buffer_load_dwordx4 v[116:119], v1, s[8:11], s38 offen offset:2560 nt
    v_add_f32 v4, v20, v21
    v_add_f32 v5, v22, v23
    v_add_f32 v4, v4, v5
    v_mov_b32 v5, v4
    s_nop 1
    v_permlane32_swap_b32 v4, v5
    v_add_f32 v4, v4, v5
    s_waitcnt vmcnt(12)
    buffer_load_dwordx4 v[24:27], v2, s[16:19], s39 offen
    buffer_load_dwordx4 v[120:123], v1, s[8:11], s38 offen offset:3072 nt
    v_perm_b32 v65, v140, v136, s36
    v_perm_b32 v69, v140, v136, s37
    v_perm_b32 v73, v141, v137, s36
    v_perm_b32 v77, v141, v137, s37
    v_perm_b32 v81, v142, v138, s36
    v_perm_b32 v85, v142, v138, s37
    v_perm_b32 v89, v143, v139, s36
    v_perm_b32 v93, v143, v139, s37
    s_waitcnt vmcnt(13)
    buffer_load_dwordx4 v[124:127], v1, s[8:11], s38 offen offset:3584 nt
    s_add_u32 s73, s73, 0x4000
    s_xor_b32 s38, s73, s72
    s_bfe_u32 s39, s38, 0xe0008
    s_mov_b64 exec, 1
    v_mov_b32 v17, 1
    buffer_atomic_add v17, off, s[32:35], s77 sc0
    s_mov_b64 exec, -1
    v_mov_b32 v5, v4
    s_nop 1
    v_permlane16_swap_b32 v4, v5
    v_add_f32 v4, v4, v5
    v_rcp_f32 v4, v4
    s_nop 0
    s_waitcnt vmcnt(14)
    buffer_load_dwordx4 v[128:131], v1, s[8:11], s38 offen offset:0 nt
    v_perm_b32 v66, v148, v144, s36
    v_perm_b32 v70, v148, v144, s37
    v_perm_b32 v74, v149, v145, s36
    v_perm_b32 v78, v149, v145, s37
    v_perm_b32 v82, v150, v146, s36
    v_perm_b32 v86, v150, v146, s37
    v_perm_b32 v90, v151, v147, s36
    v_perm_b32 v94, v151, v147, s37
    s_waitcnt vmcnt(13)
    buffer_load_dwordx4 v[132:135], v1, s[8:11], s38 offen offset:512 nt
    v_mul_f32 v20, v20, v4
    v_mul_f32 v21, v21, v4
    v_mul_f32 v22, v22, v4
    v_mul_f32 v23, v23, v4
    s_waitcnt vmcnt(13)
    buffer_load_dwordx4 v[136:139], v1, s[8:11], s38 offen offset:1024 nt
    v_perm_b32 v67, v156, v152, s36
    v_perm_b32 v71, v156, v152, s37
    v_perm_b32 v75, v157, v153, s36
    v_mfma_f32_16x16x32_bf16 v[32:35], v[28:31], v[64:67], v[32:35]
    v_perm_b32 v79, v157, v153, s37
    v_mfma_f32_16x16x32_bf16 v[36:39], v[28:31], v[68:71], v[36:39]
    v_perm_b32 v83, v158, v154, s36
    v_mfma_f32_16x16x32_bf16 v[40:43], v[28:31], v[72:75], v[40:43]
    v_perm_b32 v87, v158, v154, s37
    v_mfma_f32_16x16x32_bf16 v[44:47], v[28:31], v[76:79], v[44:47]
    v_perm_b32 v91, v159, v155, s36
    v_mfma_f32_16x16x32_bf16 v[48:51], v[28:31], v[80:83], v[48:51]
    v_perm_b32 v95, v159, v155, s37
    v_mfma_f32_16x16x32_bf16 v[52:55], v[28:31], v[84:87], v[52:55]
    v_mfma_f32_16x16x32_bf16 v[56:59], v[28:31], v[88:91], v[56:59]
    v_mfma_f32_16x16x32_bf16 v[60:63], v[28:31], v[92:95], v[60:63]
L_dyn:
    s_waitcnt vmcnt(12)
    buffer_load_dwordx4 v[140:143], v1, s[8:11], s38 offen offset:1536 nt
    s_waitcnt vmcnt(12)
    buffer_load_dwordx4 v[144:147], v1, s[8:11], s38 offen offset:2048 nt
    v_perm_b32 v64, v100, v96, s36
    v_perm_b32 v68, v100, v96, s37
    v_perm_b32 v72, v101, v97, s36
    v_perm_b32 v76, v101, v97, s37
    v_perm_b32 v80, v102, v98, s36
    v_perm_b32 v84, v102, v98, s37
    v_perm_b32 v88, v103, v99, s36
    v_perm_b32 v92, v103, v99, s37
    s_waitcnt vmcnt(12)
    buffer_load_dwordx4 v[148:151], v1, s[8:11], s38 offen offset:2560 nt
    s_waitcnt vmcnt(12)
    buffer_load_dwordx4 v[28:31], v2, s[16:19], s39 offen
    buffer_load_dwordx4 v[152:155], v1, s[8:11], s38 offen offset:3072 nt
    v_perm_b32 v65, v108, v104, s36
    v_perm_b32 v69, v108, v104, s37
    v_perm_b32 v73, v109, v105, s36
    v_perm_b32 v77, v109, v105, s37
    v_perm_b32 v81, v110, v106, s36
    v_perm_b32 v85, v110, v106, s37
    v_perm_b32 v89, v111, v107, s36
    v_perm_b32 v93, v111, v107, s37
    s_waitcnt vmcnt(13)
    buffer_load_dwordx4 v[156:159], v1, s[8:11], s38 offen offset:3584 nt
    v_readfirstlane_b32 s58, v16
    s_sub_u32 s58, s58, s29
    s_mov_b32 s56, s58
    s_cmp_ge_u32 s56, 24
    s_cbranch_scc1 L_drain0
    s_and_b32 s57, s56, 3
    s_lshl_b32 s38, s57, 14
    s_bfe_u32 s57, s56, 0x20002
    s_lshl_b32 s57, s57, 20
    s_or_b32 s38, s38, s57
    s_lshr_b32 s56, s56, 4
    s_add_u32 s56, s56, 14
    s_lshl_b32 s56, s56, 16
    s_or_b32 s38, s38, s56
    s_xor_b32 s38, s38, s78
    s_bfe_u32 s39, s38, 0xe0008
    s_mov_b64 exec, 1
    v_mov_b32 v16, 1
    buffer_atomic_add v16, off, s[32:35], s77 sc0
    s_mov_b64 exec, -1
    s_waitcnt vmcnt(14)
    buffer_load_dwordx4 v[96:99], v1, s[8:11], s38 offen offset:0 nt
    v_perm_b32 v66, v116, v112, s36
    v_perm_b32 v70, v116, v112, s37
    v_perm_b32 v74, v117, v113, s36
    v_perm_b32 v78, v117, v113, s37
    v_perm_b32 v82, v118, v114, s36
    v_perm_b32 v86, v118, v114, s37
    v_perm_b32 v90, v119, v115, s36
    v_perm_b32 v94, v119, v115, s37
    s_waitcnt vmcnt(13)
    buffer_load_dwordx4 v[100:103], v1, s[8:11], s38 offen offset:512 nt
    s_waitcnt vmcnt(13)
    buffer_load_dwordx4 v[104:107], v1, s[8:11], s38 offen offset:1024 nt
    v_perm_b32 v67, v124, v120, s36
    v_perm_b32 v71, v124, v120, s37
    v_perm_b32 v75, v125, v121, s36
    v_mfma_f32_16x16x32_bf16 v[32:35], v[24:27], v[64:67], v[32:35]
    v_perm_b32 v79, v125, v121, s37
    v_mfma_f32_16x16x32_bf16 v[36:39], v[24:27], v[68:71], v[36:39]
    v_perm_b32 v83, v126, v122, s36
    v_mfma_f32_16x16x32_bf16 v[40:43], v[24:27], v[72:75], v[40:43]
    v_perm_b32 v87, v126, v122, s37
    v_mfma_f32_16x16x32_bf16 v[44:47], v[24:27], v[76:79], v[44:47]
    v_perm_b32 v91, v127, v123, s36
    v_mfma_f32_16x16x32_bf16 v[48:51], v[24:27], v[80:83], v[48:51]
    v_perm_b32 v95, v127, v123, s37
    v_mfma_f32_16x16x32_bf16 v[52:55], v[24:27], v[84:87], v[52:55]
    v_mfma_f32_16x16x32_bf16 v[56:59], v[24:27], v[88:91], v[56:59]
    v_mfma_f32_16x16x32_bf16 v[60:63], v[24:27], v[92:95], v[60:63]
    s_waitcnt vmcnt(12)
    buffer_load_dwordx4 v[108:111], v1, s[8:11], s38 offen offset:1536 nt
    s_waitcnt vmcnt(12)
    buffer_load_dwordx4 v[112:115], v1, s[8:11], s38 offen offset:2048 nt
    v_perm_b32 v64, v132, v128, s36
    v_perm_b32 v68, v132, v128, s37
    v_perm_b32 v72, v133, v129, s36
    v_perm_b32 v76, v133, v129, s37
    v_perm_b32 v80, v134, v130, s36
    v_perm_b32 v84, v134, v130, s37
    v_perm_b32 v88, v135, v131, s36
    v_perm_b32 v92, v135, v131, s37
    s_waitcnt vmcnt(12)
    buffer_load_dwordx4 v[116:119], v1, s[8:11], s38 offen offset:2560 nt
    s_waitcnt vmcnt(12)
    buffer_load_dwordx4 v[24:27], v2, s[16:19], s39 offen
    buffer_load_dwordx4 v[120:123], v1, s[8:11], s38 offen offset:3072 nt
    v_perm_b32 v65, v140, v136, s36
    v_perm_b32 v69, v140, v136, s37
    v_perm_b32 v73, v141, v137, s36
    v_perm_b32 v77, v141, v137, s37
    v_perm_b32 v81, v142, v138, s36
    v_perm_b32 v85, v142, v138, s37
    v_perm_b32 v89, v143, v139, s36
    v_perm_b32 v93, v143, v139, s37
    s_waitcnt vmcnt(13)
    buffer_load_dwordx4 v[124:127], v1, s[8:11], s38 offen offset:3584 nt
    v_readfirstlane_b32 s58, v17
    s_sub_u32 s58, s58, s29
    s_mov_b32 s56, s58
    s_cmp_ge_u32 s56, 24
    s_cbranch_scc1 L_drain1
    s_and_b32 s57, s56, 3
    s_lshl_b32 s38, s57, 14
    s_bfe_u32 s57, s56, 0x20002
    s_lshl_b32 s57, s57, 20
    s_or_b32 s38, s38, s57
    s_lshr_b32 s56, s56, 4
    s_add_u32 s56, s56, 14
    s_lshl_b32 s56, s56, 16
    s_or_b32 s38, s38, s56
    s_xor_b32 s38, s38, s78
    s_bfe_u32 s39, s38, 0xe0008
    s_mov_b64 exec, 1
    v_mov_b32 v17, 1
    buffer_atomic_add v17, off, s[32:35], s77 sc0
    s_mov_b64 exec, -1
    s_waitcnt vmcnt(14)
    buffer_load_dwordx4 v[128:131], v1, s[8:11], s38 offen offset:0 nt
    v_perm_b32 v66, v148, v144, s36
    v_perm_b32 v70, v148, v144, s37
    v_perm_b32 v74, v149, v145, s36
    v_perm_b32 v78, v149, v145, s37
    v_perm_b32 v82, v150, v146, s36
    v_perm_b32 v86, v150, v146, s37
    v_perm_b32 v90, v151, v147, s36
    v_perm_b32 v94, v151, v147, s37
    s_waitcnt vmcnt(13)
    buffer_load_dwordx4 v[132:135], v1, s[8:11], s38 offen offset:512 nt
    s_waitcnt vmcnt(13)
    buffer_load_dwordx4 v[136:139], v1, s[8:11], s38 offen offset:1024 nt
    v_perm_b32 v67, v156, v152, s36
    v_perm_b32 v71, v156, v152, s37
    v_perm_b32 v75, v157, v153, s36
    v_mfma_f32_16x16x32_bf16 v[32:35], v[28:31], v[64:67], v[32:35]
    v_perm_b32 v79, v157, v153, s37
    v_mfma_f32_16x16x32_bf16 v[36:39], v[28:31], v[68:71], v[36:39]
    v_perm_b32 v83, v158, v154, s36
    v_mfma_f32_16x16x32_bf16 v[40:43], v[28:31], v[72:75], v[40:43]
    v_perm_b32 v87, v158, v154, s37
    v_mfma_f32_16x16x32_bf16 v[44:47], v[28:31], v[76:79], v[44:47]
    v_perm_b32 v91, v159, v155, s36
    v_mfma_f32_16x16x32_bf16 v[48:51], v[28:31], v[80:83], v[48:51]
    v_perm_b32 v95, v159, v155, s37
    v_mfma_f32_16x16x32_bf16 v[52:55], v[28:31], v[84:87], v[52:55]
    v_mfma_f32_16x16x32_bf16 v[56:59], v[28:31], v[88:91], v[56:59]
    v_mfma_f32_16x16x32_bf16 v[60:63], v[28:31], v[92:95], v[60:63]
    s_branch L_dyn
L_fdrain0:
    s_lshl_b32 s92, s3, 14
    s_xor_b32 s92, s92, s78
    s_xor_b32 s38, s92, 0x2f0000
    s_bfe_u32 s39, s38, 0xe0008
    buffer_load_dwordx4 v[220:223], v2, s[16:19], s39 offen
    buffer_load_dwordx2 v[188:189], v3, s[8:11], s38 offen offset:0 nt
    buffer_load_dwordx2 v[190:191], v3, s[8:11], s38 offen offset:512 nt
    s_waitcnt vmcnt(15)
    buffer_load_dwordx2 v[192:193], v3, s[8:11], s38 offen offset:1024 nt
    buffer_load_dwordx2 v[194:195], v3, s[8:11], s38 offen offset:1536 nt
    v_perm_b32 v66, v116, v112, s36
    v_perm_b32 v70, v116, v112, s37
    v_perm_b32 v74, v117, v113, s36
    v_perm_b32 v78, v117, v113, s37
    v_perm_b32 v82, v118, v114, s36
    v_perm_b32 v86, v118, v114, s37
    v_perm_b32 v90, v119, v115, s36
    v_perm_b32 v94, v119, v115, s37
    s_waitcnt vmcnt(15)
    buffer_load_dwordx2 v[196:197], v3, s[8:11], s38 offen offset:2048 nt
    buffer_load_dwordx2 v[198:199], v3, s[8:11], s38 offen offset:2560 nt
    s_waitcnt vmcnt(16)
    buffer_load_dwordx2 v[200:201], v3, s[8:11], s38 offen offset:3072 nt
    buffer_load_dwordx2 v[202:203], v3, s[8:11], s38 offen offset:3584 nt
    v_perm_b32 v67, v124, v120, s36
    v_perm_b32 v71, v124, v120, s37
    v_perm_b32 v75, v125, v121, s36
    v_mfma_f32_16x16x32_bf16 v[32:35], v[24:27], v[64:67], v[32:35]
    v_perm_b32 v79, v125, v121, s37
    v_mfma_f32_16x16x32_bf16 v[36:39], v[24:27], v[68:71], v[36:39]
    v_perm_b32 v83, v126, v122, s36
    v_mfma_f32_16x16x32_bf16 v[40:43], v[24:27], v[72:75], v[40:43]
    v_perm_b32 v87, v126, v122, s37
    v_mfma_f32_16x16x32_bf16 v[44:47], v[24:27], v[76:79], v[44:47]
    v_perm_b32 v91, v127, v123, s36
    v_mfma_f32_16x16x32_bf16 v[48:51], v[24:27], v[80:83], v[48:51]
    v_perm_b32 v95, v127, v123, s37
    v_mfma_f32_16x16x32_bf16 v[52:55], v[24:27], v[84:87], v[52:55]
    v_mfma_f32_16x16x32_bf16 v[56:59], v[24:27], v[88:91], v[56:59]
    v_mfma_f32_16x16x32_bf16 v[60:63], v[24:27], v[92:95], v[60:63]
    s_waitcnt vmcnt(17)
    s_xor_b32 s38, s92, 0x2f8000
    s_bfe_u32 s39, s38, 0xe0008
    buffer_load_dwordx4 v[224:227], v2, s[16:19], s39 offen
    buffer_load_dwordx2 v[204:205], v3, s[8:11], s38 offen offset:0 nt
    buffer_load_dwordx2 v[206:207], v3, s[8:11], s38 offen offset:512 nt
    s_waitcnt vmcnt(19)
    buffer_load_dwordx2 v[208:209], v3, s[8:11], s38 offen offset:1024 nt
    buffer_load_dwordx2 v[210:211], v3, s[8:11], s38 offen offset:1536 nt
    v_perm_b32 v64, v132, v128, s36
    v_perm_b32 v68, v132, v128, s37
    v_perm_b32 v72, v133, v129, s36
    v_perm_b32 v76, v133, v129, s37
    v_perm_b32 v80, v134, v130, s36
    v_perm_b32 v84, v134, v130, s37
    v_perm_b32 v88, v135, v131, s36
    v_perm_b32 v92, v135, v131, s37
    s_waitcnt vmcnt(20)
    buffer_load_dwordx2 v[212:213], v3, s[8:11], s38 offen offset:2048 nt
    buffer_load_dwordx2 v[214:215], v3, s[8:11], s38 offen offset:2560 nt
    s_waitcnt vmcnt(21)
    buffer_load_dwordx2 v[216:217], v3, s[8:11], s38 offen offset:3072 nt
    buffer_load_dwordx2 v[218:219], v3, s[8:11], s38 offen offset:3584 nt
    v_perm_b32 v65, v140, v136, s36
    v_perm_b32 v69, v140, v136, s37
    v_perm_b32 v73, v141, v137, s36
    v_perm_b32 v77, v141, v137, s37
    v_perm_b32 v81, v142, v138, s36
    v_perm_b32 v85, v142, v138, s37
    v_perm_b32 v89, v143, v139, s36
    v_perm_b32 v93, v143, v139, s37
    s_waitcnt vmcnt(22)
    s_xor_b32 s38, s92, 0x3f0000
    s_bfe_u32 s39, s38, 0xe0008
    buffer_load_dwordx4 v[228:231], v2, s[16:19], s39 offen
    buffer_load_dwordx2 v[96:97], v3, s[8:11], s38 offen offset:0 nt
    buffer_load_dwordx2 v[98:99], v3, s[8:11], s38 offen offset:512 nt
    s_waitcnt vmcnt(24)
    buffer_load_dwordx2 v[100:101], v3, s[8:11], s38 offen offset:1024 nt
    buffer_load_dwordx2 v[102:103], v3, s[8:11], s38 offen offset:1536 nt
    v_perm_b32 v66, v148, v144, s36
    v_perm_b32 v70, v148, v144, s37
    v_perm_b32 v74, v149, v145, s36
    v_perm_b32 v78, v149, v145, s37
    v_perm_b32 v82, v150, v146, s36
    v_perm_b32 v86, v150, v146, s37
    v_perm_b32 v90, v151, v147, s36
    v_perm_b32 v94, v151, v147, s37
    s_waitcnt vmcnt(24)
    buffer_load_dwordx2 v[104:105], v3, s[8:11], s38 offen offset:2048 nt
    buffer_load_dwordx2 v[106:107], v3, s[8:11], s38 offen offset:2560 nt
    s_waitcnt vmcnt(25)
    buffer_load_dwordx2 v[108:109], v3, s[8:11], s38 offen offset:3072 nt
    buffer_load_dwordx2 v[110:111], v3, s[8:11], s38 offen offset:3584 nt
    v_perm_b32 v67, v156, v152, s36
    v_perm_b32 v71, v156, v152, s37
    v_perm_b32 v75, v157, v153, s36
    v_mfma_f32_16x16x32_bf16 v[32:35], v[28:31], v[64:67], v[32:35]
    v_perm_b32 v79, v157, v153, s37
    v_mfma_f32_16x16x32_bf16 v[36:39], v[28:31], v[68:71], v[36:39]
    v_perm_b32 v83, v158, v154, s36
    v_mfma_f32_16x16x32_bf16 v[40:43], v[28:31], v[72:75], v[40:43]
    v_perm_b32 v87, v158, v154, s37
    v_mfma_f32_16x16x32_bf16 v[44:47], v[28:31], v[76:79], v[44:47]
    v_perm_b32 v91, v159, v155, s36
    v_mfma_f32_16x16x32_bf16 v[48:51], v[28:31], v[80:83], v[48:51]
    v_perm_b32 v95, v159, v155, s37
    v_mfma_f32_16x16x32_bf16 v[52:55], v[28:31], v[84:87], v[52:55]
    v_mfma_f32_16x16x32_bf16 v[56:59], v[28:31], v[88:91], v[56:59]
    v_mfma_f32_16x16x32_bf16 v[60:63], v[28:31], v[92:95], v[60:63]
    s_xor_b32 s38, s92, 0x3f8000
    s_bfe_u32 s39, s38, 0xe0008
    buffer_load_dwordx4 v[232:235], v2, s[16:19], s39 offen
    buffer_load_dwordx2 v[112:113], v3, s[8:11], s38 offen offset:0 nt
    buffer_load_dwordx2 v[114:115], v3, s[8:11], s38 offen offset:512 nt
    buffer_load_dwordx2 v[116:117], v3, s[8:11], s38 offen offset:1024 nt
    buffer_load_dwordx2 v[118:119], v3, s[8:11], s38 offen offset:1536 nt
    buffer_load_dwordx2 v[120:121], v3, s[8:11], s38 offen offset:2048 nt
    buffer_load_dwordx2 v[122:123], v3, s[8:11], s38 offen offset:2560 nt
    buffer_load_dwordx2 v[124:125], v3, s[8:11], s38 offen offset:3072 nt
    buffer_load_dwordx2 v[126:127], v3, s[8:11], s38 offen offset:3584 nt
    v_mov_b32 v177, s28
    v_mul_f32 v64, v20, v32
    v_fmac_f32 v64, v21, v33
    v_fmac_f32 v64, v22, v34
    v_fmac_f32 v64, v23, v35
    v_mul_f32 v65, v20, v36
    v_fmac_f32 v65, v21, v37
    v_fmac_f32 v65, v22, v38
    v_fmac_f32 v65, v23, v39
    v_mul_f32 v66, v20, v40
    v_fmac_f32 v66, v21, v41
    v_fmac_f32 v66, v22, v42
    v_fmac_f32 v66, v23, v43
    v_mul_f32 v67, v20, v44
    v_fmac_f32 v67, v21, v45
    v_fmac_f32 v67, v22, v46
    v_fmac_f32 v67, v23, v47
    v_mul_f32 v68, v20, v48
    v_fmac_f32 v68, v21, v49
    v_fmac_f32 v68, v22, v50
    v_fmac_f32 v68, v23, v51
    v_mul_f32 v69, v20, v52
    v_fmac_f32 v69, v21, v53
    v_fmac_f32 v69, v22, v54
    v_fmac_f32 v69, v23, v55
    v_mul_f32 v70, v20, v56
    v_fmac_f32 v70, v21, v57
    v_fmac_f32 v70, v22, v58
    v_fmac_f32 v70, v23, v59
    v_mul_f32 v71, v20, v60
    v_fmac_f32 v71, v21, v61
    v_fmac_f32 v71, v22, v62
    v_fmac_f32 v71, v23, v63
    v_mov_b32 v179, s28
    s_mov_b32 s62, 0
    v_permlane32_swap_b32 v64, v68
    v_permlane32_swap_b32 v65, v69
    v_permlane32_swap_b32 v66, v70
    v_permlane32_swap_b32 v67, v71
    v_add_f32 v64, v64, v68
    v_add_f32 v65, v65, v69
    v_add_f32 v66, v66, v70
    v_add_f32 v67, v67, v71
    s_nop 1
    v_permlane16_swap_b32 v64, v66
    v_permlane16_swap_b32 v65, v67
    v_add_f32 v176, v64, v66
    v_add_f32 v178, v65, v67
    buffer_store_dwordx4 v[176:179], v13, s[32:35], s60 offen sc1
    s_waitcnt vmcnt(34)
    v_perm_b32 v80, v190, v188, s36
    v_perm_b32 v84, v190, v188, s37
    v_perm_b32 v88, v191, v189, s36
    v_perm_b32 v92, v191, v189, s37
    s_waitcnt vmcnt(32)
    v_perm_b32 v81, v194, v192, s36
    v_perm_b32 v85, v194, v192, s37
    v_perm_b32 v89, v195, v193, s36
    v_perm_b32 v93, v195, v193, s37
    s_waitcnt vmcnt(30)
    v_perm_b32 v82, v198, v196, s36
    v_perm_b32 v86, v198, v196, s37
    v_perm_b32 v90, v199, v197, s36
    v_perm_b32 v94, v199, v197, s37
    s_waitcnt vmcnt(28)
    v_perm_b32 v83, v202, v200, s36
    v_perm_b32 v87, v202, v200, s37
    v_perm_b32 v91, v203, v201, s36
    v_perm_b32 v95, v203, v201, s37
    v_mfma_f32_16x16x32_bf16 v[236:239], v[220:223], v[80:83], 0
    v_mfma_f32_16x16x32_bf16 v[240:243], v[220:223], v[84:87], 0
    v_mfma_f32_16x16x32_bf16 v[244:247], v[220:223], v[88:91], 0
    v_mfma_f32_16x16x32_bf16 v[248:251], v[220:223], v[92:95], 0
    s_waitcnt vmcnt(25)
    v_perm_b32 v80, v206, v204, s36
    v_perm_b32 v84, v206, v204, s37
    v_perm_b32 v88, v207, v205, s36
    v_perm_b32 v92, v207, v205, s37
    s_waitcnt vmcnt(23)
    v_perm_b32 v81, v210, v208, s36
    v_perm_b32 v85, v210, v208, s37
    v_perm_b32 v89, v211, v209, s36
    v_perm_b32 v93, v211, v209, s37
    s_waitcnt vmcnt(21)
    v_perm_b32 v82, v214, v212, s36
    v_perm_b32 v86, v214, v212, s37
    v_perm_b32 v90, v215, v213, s36
    v_perm_b32 v94, v215, v213, s37
    s_waitcnt vmcnt(19)
    v_perm_b32 v83, v218, v216, s36
    v_perm_b32 v87, v218, v216, s37
    v_perm_b32 v91, v219, v217, s36
    v_perm_b32 v95, v219, v217, s37
    v_mfma_f32_16x16x32_bf16 v[236:239], v[224:227], v[80:83], v[236:239]
    v_mfma_f32_16x16x32_bf16 v[240:243], v[224:227], v[84:87], v[240:243]
    v_mfma_f32_16x16x32_bf16 v[244:247], v[224:227], v[88:91], v[244:247]
    v_mfma_f32_16x16x32_bf16 v[248:251], v[224:227], v[92:95], v[248:251]
    s_waitcnt vmcnt(16)
    v_perm_b32 v80, v98, v96, s36
    v_perm_b32 v84, v98, v96, s37
    v_perm_b32 v88, v99, v97, s36
    v_perm_b32 v92, v99, v97, s37
    s_waitcnt vmcnt(14)
    v_perm_b32 v81, v102, v100, s36
    v_perm_b32 v85, v102, v100, s37
    v_perm_b32 v89, v103, v101, s36
    v_perm_b32 v93, v103, v101, s37
    s_waitcnt vmcnt(12)
    v_perm_b32 v82, v106, v104, s36
    v_perm_b32 v86, v106, v104, s37
    v_perm_b32 v90, v107, v105, s36
    v_perm_b32 v94, v107, v105, s37
    s_waitcnt vmcnt(10)
    v_perm_b32 v83, v110, v108, s36
    v_perm_b32 v87, v110, v108, s37
    v_perm_b32 v91, v111, v109, s36
    v_perm_b32 v95, v111, v109, s37
    v_mfma_f32_16x16x32_bf16 v[236:239], v[228:231], v[80:83], v[236:239]
    v_mfma_f32_16x16x32_bf16 v[240:243], v[228:231], v[84:87], v[240:243]
    v_mfma_f32_16x16x32_bf16 v[244:247], v[228:231], v[88:91], v[244:247]
    v_mfma_f32_16x16x32_bf16 v[248:251], v[228:231], v[92:95], v[248:251]
    s_waitcnt vmcnt(7)
    v_perm_b32 v80, v114, v112, s36
    v_perm_b32 v84, v114, v112, s37
    v_perm_b32 v88, v115, v113, s36
    v_perm_b32 v92, v115, v113, s37
    s_waitcnt vmcnt(5)
    v_perm_b32 v81, v118, v116, s36
    v_perm_b32 v85, v118, v116, s37
    v_perm_b32 v89, v119, v117, s36
    v_perm_b32 v93, v119, v117, s37
    buffer_load_dwordx2 v[160:161], v14, s[32:35], s81 offen offset:0 sc1
    buffer_load_dwordx2 v[162:163], v14, s[32:35], s81 offen offset:2048 sc1
    buffer_load_dwordx2 v[164:165], v14, s[32:35], s82 offen offset:0 sc1
    buffer_load_dwordx2 v[166:167], v14, s[32:35], s82 offen offset:2048 sc1
    s_waitcnt vmcnt(7)
    v_perm_b32 v82, v122, v120, s36
    v_perm_b32 v86, v122, v120, s37
    v_perm_b32 v90, v123, v121, s36
    v_perm_b32 v94, v123, v121, s37
    s_waitcnt vmcnt(5)
    v_perm_b32 v83, v126, v124, s36
    v_perm_b32 v87, v126, v124, s37
    v_perm_b32 v91, v127, v125, s36
    v_perm_b32 v95, v127, v125, s37
    v_mfma_f32_16x16x32_bf16 v[236:239], v[232:235], v[80:83], v[236:239]
    v_mfma_f32_16x16x32_bf16 v[240:243], v[232:235], v[84:87], v[240:243]
    v_mfma_f32_16x16x32_bf16 v[244:247], v[232:235], v[88:91], v[244:247]
    v_mfma_f32_16x16x32_bf16 v[248:251], v[232:235], v[92:95], v[248:251]
    s_branch L_col
L_fdrain8:
    s_lshl_b32 s92, s3, 14
    s_xor_b32 s92, s92, s78
    s_xor_b32 s38, s92, 0x2f0000
    s_bfe_u32 s39, s38, 0xe0008
    buffer_load_dwordx4 v[220:223], v2, s[16:19], s39 offen
    buffer_load_dwordx2 v[188:189], v3, s[8:11], s38 offen offset:0 nt
    buffer_load_dwordx2 v[190:191], v3, s[8:11], s38 offen offset:512 nt
    s_waitcnt vmcnt(15)
    buffer_load_dwordx2 v[192:193], v3, s[8:11], s38 offen offset:1024 nt
    buffer_load_dwordx2 v[194:195], v3, s[8:11], s38 offen offset:1536 nt
    v_perm_b32 v66, v148, v144, s36
    v_perm_b32 v70, v148, v144, s37
    v_perm_b32 v74, v149, v145, s36
    v_perm_b32 v78, v149, v145, s37
    v_perm_b32 v82, v150, v146, s36
    v_perm_b32 v86, v150, v146, s37
    v_perm_b32 v90, v151, v147, s36
    v_perm_b32 v94, v151, v147, s37
    s_waitcnt vmcnt(15)
    buffer_load_dwordx2 v[196:197], v3, s[8:11], s38 offen offset:2048 nt
    buffer_load_dwordx2 v[198:199], v3, s[8:11], s38 offen offset:2560 nt
    s_waitcnt vmcnt(16)
    buffer_load_dwordx2 v[200:201], v3, s[8:11], s38 offen offset:3072 nt
    buffer_load_dwordx2 v[202:203], v3, s[8:11], s38 offen offset:3584 nt
    v_perm_b32 v67, v156, v152, s36
    v_perm_b32 v71, v156, v152, s37
    v_perm_b32 v75, v157, v153, s36
    v_mfma_f32_16x16x32_bf16 v[32:35], v[28:31], v[64:67], v[32:35]
    v_perm_b32 v79, v157, v153, s37
    v_mfma_f32_16x16x32_bf16 v[36:39], v[28:31], v[68:71], v[36:39]
    v_perm_b32 v83, v158, v154, s36
    v_mfma_f32_16x16x32_bf16 v[40:43], v[28:31], v[72:75], v[40:43]
    v_perm_b32 v87, v158, v154, s37
    v_mfma_f32_16x16x32_bf16 v[44:47], v[28:31], v[76:79], v[44:47]
    v_perm_b32 v91, v159, v155, s36
    v_mfma_f32_16x16x32_bf16 v[48:51], v[28:31], v[80:83], v[48:51]
    v_perm_b32 v95, v159, v155, s37
    v_mfma_f32_16x16x32_bf16 v[52:55], v[28:31], v[84:87], v[52:55]
    v_mfma_f32_16x16x32_bf16 v[56:59], v[28:31], v[88:91], v[56:59]
    v_mfma_f32_16x16x32_bf16 v[60:63], v[28:31], v[92:95], v[60:63]
    s_waitcnt vmcnt(17)
    s_xor_b32 s38, s92, 0x2f8000
    s_bfe_u32 s39, s38, 0xe0008
    buffer_load_dwordx4 v[224:227], v2, s[16:19], s39 offen
    buffer_load_dwordx2 v[204:205], v3, s[8:11], s38 offen offset:0 nt
    buffer_load_dwordx2 v[206:207], v3, s[8:11], s38 offen offset:512 nt
    s_waitcnt vmcnt(19)
    buffer_load_dwordx2 v[208:209], v3, s[8:11], s38 offen offset:1024 nt
    buffer_load_dwordx2 v[210:211], v3, s[8:11], s38 offen offset:1536 nt
    v_perm_b32 v64, v100, v96, s36
    v_perm_b32 v68, v100, v96, s37
    v_perm_b32 v72, v101, v97, s36
    v_perm_b32 v76, v101, v97, s37
    v_perm_b32 v80, v102, v98, s36
    v_perm_b32 v84, v102, v98, s37
    v_perm_b32 v88, v103, v99, s36
    v_perm_b32 v92, v103, v99, s37
    s_waitcnt vmcnt(20)
    buffer_load_dwordx2 v[212:213], v3, s[8:11], s38 offen offset:2048 nt
    buffer_load_dwordx2 v[214:215], v3, s[8:11], s38 offen offset:2560 nt
    s_waitcnt vmcnt(21)
    buffer_load_dwordx2 v[216:217], v3, s[8:11], s38 offen offset:3072 nt
    buffer_load_dwordx2 v[218:219], v3, s[8:11], s38 offen offset:3584 nt
    v_perm_b32 v65, v108, v104, s36
    v_perm_b32 v69, v108, v104, s37
    v_perm_b32 v73, v109, v105, s36
    v_perm_b32 v77, v109, v105, s37
    v_perm_b32 v81, v110, v106, s36
    v_perm_b32 v85, v110, v106, s37
    v_perm_b32 v89, v111, v107, s36
    v_perm_b32 v93, v111, v107, s37
    s_waitcnt vmcnt(22)
    s_xor_b32 s38, s92, 0x3f0000
    s_bfe_u32 s39, s38, 0xe0008
    buffer_load_dwordx4 v[228:231], v2, s[16:19], s39 offen
    buffer_load_dwordx2 v[128:129], v3, s[8:11], s38 offen offset:0 nt
    buffer_load_dwordx2 v[130:131], v3, s[8:11], s38 offen offset:512 nt
    s_waitcnt vmcnt(24)
    buffer_load_dwordx2 v[132:133], v3, s[8:11], s38 offen offset:1024 nt
    buffer_load_dwordx2 v[134:135], v3, s[8:11], s38 offen offset:1536 nt
    v_perm_b32 v66, v116, v112, s36
    v_perm_b32 v70, v116, v112, s37
    v_perm_b32 v74, v117, v113, s36
    v_perm_b32 v78, v117, v113, s37
    v_perm_b32 v82, v118, v114, s36
    v_perm_b32 v86, v118, v114, s37
    v_perm_b32 v90, v119, v115, s36
    v_perm_b32 v94, v119, v115, s37
    s_waitcnt vmcnt(24)
    buffer_load_dwordx2 v[136:137], v3, s[8:11], s38 offen offset:2048 nt
    buffer_load_dwordx2 v[138:139], v3, s[8:11], s38 offen offset:2560 nt
    s_waitcnt vmcnt(25)
    buffer_load_dwordx2 v[140:141], v3, s[8:11], s38 offen offset:3072 nt
    buffer_load_dwordx2 v[142:143], v3, s[8:11], s38 offen offset:3584 nt
    v_perm_b32 v67, v124, v120, s36
    v_perm_b32 v71, v124, v120, s37
    v_perm_b32 v75, v125, v121, s36
    v_mfma_f32_16x16x32_bf16 v[32:35], v[24:27], v[64:67], v[32:35]
    v_perm_b32 v79, v125, v121, s37
    v_mfma_f32_16x16x32_bf16 v[36:39], v[24:27], v[68:71], v[36:39]
    v_perm_b32 v83, v126, v122, s36
    v_mfma_f32_16x16x32_bf16 v[40:43], v[24:27], v[72:75], v[40:43]
    v_perm_b32 v87, v126, v122, s37
    v_mfma_f32_16x16x32_bf16 v[44:47], v[24:27], v[76:79], v[44:47]
    v_perm_b32 v91, v127, v123, s36
    v_mfma_f32_16x16x32_bf16 v[48:51], v[24:27], v[80:83], v[48:51]
    v_perm_b32 v95, v127, v123, s37
    v_mfma_f32_16x16x32_bf16 v[52:55], v[24:27], v[84:87], v[52:55]
    v_mfma_f32_16x16x32_bf16 v[56:59], v[24:27], v[88:91], v[56:59]
    v_mfma_f32_16x16x32_bf16 v[60:63], v[24:27], v[92:95], v[60:63]
    s_xor_b32 s38, s92, 0x3f8000
    s_bfe_u32 s39, s38, 0xe0008
    buffer_load_dwordx4 v[232:235], v2, s[16:19], s39 offen
    buffer_load_dwordx2 v[144:145], v3, s[8:11], s38 offen offset:0 nt
    buffer_load_dwordx2 v[146:147], v3, s[8:11], s38 offen offset:512 nt
    buffer_load_dwordx2 v[148:149], v3, s[8:11], s38 offen offset:1024 nt
    buffer_load_dwordx2 v[150:151], v3, s[8:11], s38 offen offset:1536 nt
    buffer_load_dwordx2 v[152:153], v3, s[8:11], s38 offen offset:2048 nt
    buffer_load_dwordx2 v[154:155], v3, s[8:11], s38 offen offset:2560 nt
    buffer_load_dwordx2 v[156:157], v3, s[8:11], s38 offen offset:3072 nt
    buffer_load_dwordx2 v[158:159], v3, s[8:11], s38 offen offset:3584 nt
    v_mov_b32 v177, s28
    v_mul_f32 v64, v20, v32
    v_fmac_f32 v64, v21, v33
    v_fmac_f32 v64, v22, v34
    v_fmac_f32 v64, v23, v35
    v_mul_f32 v65, v20, v36
    v_fmac_f32 v65, v21, v37
    v_fmac_f32 v65, v22, v38
    v_fmac_f32 v65, v23, v39
    v_mul_f32 v66, v20, v40
    v_fmac_f32 v66, v21, v41
    v_fmac_f32 v66, v22, v42
    v_fmac_f32 v66, v23, v43
    v_mul_f32 v67, v20, v44
    v_fmac_f32 v67, v21, v45
    v_fmac_f32 v67, v22, v46
    v_fmac_f32 v67, v23, v47
    v_mul_f32 v68, v20, v48
    v_fmac_f32 v68, v21, v49
    v_fmac_f32 v68, v22, v50
    v_fmac_f32 v68, v23, v51
    v_mul_f32 v69, v20, v52
    v_fmac_f32 v69, v21, v53
    v_fmac_f32 v69, v22, v54
    v_fmac_f32 v69, v23, v55
    v_mul_f32 v70, v20, v56
    v_fmac_f32 v70, v21, v57
    v_fmac_f32 v70, v22, v58
    v_fmac_f32 v70, v23, v59
    v_mul_f32 v71, v20, v60
    v_fmac_f32 v71, v21, v61
    v_fmac_f32 v71, v22, v62
    v_fmac_f32 v71, v23, v63
    v_mov_b32 v179, s28
    s_mov_b32 s62, 0
    v_permlane32_swap_b32 v64, v68
    v_permlane32_swap_b32 v65, v69
    v_permlane32_swap_b32 v66, v70
    v_permlane32_swap_b32 v67, v71
    v_add_f32 v64, v64, v68
    v_add_f32 v65, v65, v69
    v_add_f32 v66, v66, v70
    v_add_f32 v67, v67, v71
    s_nop 1
    v_permlane16_swap_b32 v64, v66
    v_permlane16_swap_b32 v65, v67
    v_add_f32 v176, v64, v66
    v_add_f32 v178, v65, v67
    buffer_store_dwordx4 v[176:179], v13, s[32:35], s60 offen sc1
    s_waitcnt vmcnt(34)
    v_perm_b32 v80, v190, v188, s36
    v_perm_b32 v84, v190, v188, s37
    v_perm_b32 v88, v191, v189, s36
    v_perm_b32 v92, v191, v189, s37
    s_waitcnt vmcnt(32)
    v_perm_b32 v81, v194, v192, s36
    v_perm_b32 v85, v194, v192, s37
    v_perm_b32 v89, v195, v193, s36
    v_perm_b32 v93, v195, v193, s37
    s_waitcnt vmcnt(30)
    v_perm_b32 v82, v198, v196, s36
    v_perm_b32 v86, v198, v196, s37
    v_perm_b32 v90, v199, v197, s36
    v_perm_b32 v94, v199, v197, s37
    s_waitcnt vmcnt(28)
    v_perm_b32 v83, v202, v200, s36
    v_perm_b32 v87, v202, v200, s37
    v_perm_b32 v91, v203, v201, s36
    v_perm_b32 v95, v203, v201, s37
    v_mfma_f32_16x16x32_bf16 v[236:239], v[220:223], v[80:83], 0
    v_mfma_f32_16x16x32_bf16 v[240:243], v[220:223], v[84:87], 0
    v_mfma_f32_16x16x32_bf16 v[244:247], v[220:223], v[88:91], 0
    v_mfma_f32_16x16x32_bf16 v[248:251], v[220:223], v[92:95], 0
    s_waitcnt vmcnt(25)
    v_perm_b32 v80, v206, v204, s36
    v_perm_b32 v84, v206, v204, s37
    v_perm_b32 v88, v207, v205, s36
    v_perm_b32 v92, v207, v205, s37
    s_waitcnt vmcnt(23)
    v_perm_b32 v81, v210, v208, s36
    v_perm_b32 v85, v210, v208, s37
    v_perm_b32 v89, v211, v209, s36
    v_perm_b32 v93, v211, v209, s37
    s_waitcnt vmcnt(21)
    v_perm_b32 v82, v214, v212, s36
    v_perm_b32 v86, v214, v212, s37
    v_perm_b32 v90, v215, v213, s36
    v_perm_b32 v94, v215, v213, s37
    s_waitcnt vmcnt(19)
    v_perm_b32 v83, v218, v216, s36
    v_perm_b32 v87, v218, v216, s37
    v_perm_b32 v91, v219, v217, s36
    v_perm_b32 v95, v219, v217, s37
    v_mfma_f32_16x16x32_bf16 v[236:239], v[224:227], v[80:83], v[236:239]
    v_mfma_f32_16x16x32_bf16 v[240:243], v[224:227], v[84:87], v[240:243]
    v_mfma_f32_16x16x32_bf16 v[244:247], v[224:227], v[88:91], v[244:247]
    v_mfma_f32_16x16x32_bf16 v[248:251], v[224:227], v[92:95], v[248:251]
    s_waitcnt vmcnt(16)
    v_perm_b32 v80, v130, v128, s36
    v_perm_b32 v84, v130, v128, s37
    v_perm_b32 v88, v131, v129, s36
    v_perm_b32 v92, v131, v129, s37
    s_waitcnt vmcnt(14)
    v_perm_b32 v81, v134, v132, s36
    v_perm_b32 v85, v134, v132, s37
    v_perm_b32 v89, v135, v133, s36
    v_perm_b32 v93, v135, v133, s37
    s_waitcnt vmcnt(12)
    v_perm_b32 v82, v138, v136, s36
    v_perm_b32 v86, v138, v136, s37
    v_perm_b32 v90, v139, v137, s36
    v_perm_b32 v94, v139, v137, s37
    s_waitcnt vmcnt(10)
    v_perm_b32 v83, v142, v140, s36
    v_perm_b32 v87, v142, v140, s37
    v_perm_b32 v91, v143, v141, s36
    v_perm_b32 v95, v143, v141, s37
    v_mfma_f32_16x16x32_bf16 v[236:239], v[228:231], v[80:83], v[236:239]
    v_mfma_f32_16x16x32_bf16 v[240:243], v[228:231], v[84:87], v[240:243]
    v_mfma_f32_16x16x32_bf16 v[244:247], v[228:231], v[88:91], v[244:247]
    v_mfma_f32_16x16x32_bf16 v[248:251], v[228:231], v[92:95], v[248:251]
    s_waitcnt vmcnt(7)
    v_perm_b32 v80, v146, v144, s36
    v_perm_b32 v84, v146, v144, s37
    v_perm_b32 v88, v147, v145, s36
    v_perm_b32 v92, v147, v145, s37
    s_waitcnt vmcnt(5)
    v_perm_b32 v81, v150, v148, s36
    v_perm_b32 v85, v150, v148, s37
    v_perm_b32 v89, v151, v149, s36
    v_perm_b32 v93, v151, v149, s37
    buffer_load_dwordx2 v[160:161], v14, s[32:35], s81 offen offset:0 sc1
    buffer_load_dwordx2 v[162:163], v14, s[32:35], s81 offen offset:2048 sc1
    buffer_load_dwordx2 v[164:165], v14, s[32:35], s82 offen offset:0 sc1
    buffer_load_dwordx2 v[166:167], v14, s[32:35], s82 offen offset:2048 sc1
    s_waitcnt vmcnt(7)
    v_perm_b32 v82, v154, v152, s36
    v_perm_b32 v86, v154, v152, s37
    v_perm_b32 v90, v155, v153, s36
    v_perm_b32 v94, v155, v153, s37
    s_waitcnt vmcnt(5)
    v_perm_b32 v83, v158, v156, s36
    v_perm_b32 v87, v158, v156, s37
    v_perm_b32 v91, v159, v157, s36
    v_perm_b32 v95, v159, v157, s37
    v_mfma_f32_16x16x32_bf16 v[236:239], v[232:235], v[80:83], v[236:239]
    v_mfma_f32_16x16x32_bf16 v[240:243], v[232:235], v[84:87], v[240:243]
    v_mfma_f32_16x16x32_bf16 v[244:247], v[232:235], v[88:91], v[244:247]
    v_mfma_f32_16x16x32_bf16 v[248:251], v[232:235], v[92:95], v[248:251]
    s_branch L_col
L_drain0:
    s_cmp_eq_u32 s90, 0
    s_cbranch_scc1 L_fdrain0
    s_waitcnt vmcnt(12)
    v_perm_b32 v66, v116, v112, s36
    v_perm_b32 v70, v116, v112, s37
    v_perm_b32 v74, v117, v113, s36
    v_perm_b32 v78, v117, v113, s37
    v_perm_b32 v82, v118, v114, s36
    v_perm_b32 v86, v118, v114, s37
    v_perm_b32 v90, v119, v115, s36
    v_perm_b32 v94, v119, v115, s37
    s_waitcnt vmcnt(9)
    v_perm_b32 v67, v124, v120, s36
    v_perm_b32 v71, v124, v120, s37
    v_perm_b32 v75, v125, v121, s36
    v_mfma_f32_16x16x32_bf16 v[32:35], v[24:27], v[64:67], v[32:35]
    v_perm_b32 v79, v125, v121, s37
    v_mfma_f32_16x16x32_bf16 v[36:39], v[24:27], v[68:71], v[36:39]
    v_perm_b32 v83, v126, v122, s36
    v_mfma_f32_16x16x32_bf16 v[40:43], v[24:27], v[72:75], v[40:43]
    v_perm_b32 v87, v126, v122, s37
    v_mfma_f32_16x16x32_bf16 v[44:47], v[24:27], v[76:79], v[44:47]
    v_perm_b32 v91, v127, v123, s36
    v_mfma_f32_16x16x32_bf16 v[48:51], v[24:27], v[80:83], v[48:51]
    v_perm_b32 v95, v127, v123, s37
    v_mfma_f32_16x16x32_bf16 v[52:55], v[24:27], v[84:87], v[52:55]
    v_mfma_f32_16x16x32_bf16 v[56:59], v[24:27], v[88:91], v[56:59]
    v_mfma_f32_16x16x32_bf16 v[60:63], v[24:27], v[92:95], v[60:63]
    s_waitcnt vmcnt(7)
    v_perm_b32 v64, v132, v128, s36
    v_perm_b32 v68, v132, v128, s37
    v_perm_b32 v72, v133, v129, s36
    v_perm_b32 v76, v133, v129, s37
    v_perm_b32 v80, v134, v130, s36
    v_perm_b32 v84, v134, v130, s37
    v_perm_b32 v88, v135, v131, s36
    v_perm_b32 v92, v135, v131, s37
    s_waitcnt vmcnt(5)
    v_perm_b32 v65, v140, v136, s36
    v_perm_b32 v69, v140, v136, s37
    v_perm_b32 v73, v141, v137, s36
    v_perm_b32 v77, v141, v137, s37
    v_perm_b32 v81, v142, v138, s36
    v_perm_b32 v85, v142, v138, s37
    v_perm_b32 v89, v143, v139, s36
    v_perm_b32 v93, v143, v139, s37
    s_waitcnt vmcnt(3)
    v_perm_b32 v66, v148, v144, s36
    v_perm_b32 v70, v148, v144, s37
    v_perm_b32 v74, v149, v145, s36
    v_perm_b32 v78, v149, v145, s37
    v_perm_b32 v82, v150, v146, s36
    v_perm_b32 v86, v150, v146, s37
    v_perm_b32 v90, v151, v147, s36
    v_perm_b32 v94, v151, v147, s37
    s_waitcnt vmcnt(0)
    v_perm_b32 v67, v156, v152, s36
    v_perm_b32 v71, v156, v152, s37
    v_perm_b32 v75, v157, v153, s36
    v_mfma_f32_16x16x32_bf16 v[32:35], v[28:31], v[64:67], v[32:35]
    v_perm_b32 v79, v157, v153, s37
    v_mfma_f32_16x16x32_bf16 v[36:39], v[28:31], v[68:71], v[36:39]
    v_perm_b32 v83, v158, v154, s36
    v_mfma_f32_16x16x32_bf16 v[40:43], v[28:31], v[72:75], v[40:43]
    v_perm_b32 v87, v158, v154, s37
    v_mfma_f32_16x16x32_bf16 v[44:47], v[28:31], v[76:79], v[44:47]
    v_perm_b32 v91, v159, v155, s36
    v_mfma_f32_16x16x32_bf16 v[48:51], v[28:31], v[80:83], v[48:51]
    v_perm_b32 v95, v159, v155, s37
    v_mfma_f32_16x16x32_bf16 v[52:55], v[28:31], v[84:87], v[52:55]
    v_mfma_f32_16x16x32_bf16 v[56:59], v[28:31], v[88:91], v[56:59]
    v_mfma_f32_16x16x32_bf16 v[60:63], v[28:31], v[92:95], v[60:63]
    s_branch L_epi
L_drain1:
    s_cmp_eq_u32 s90, 0
    s_cbranch_scc1 L_fdrain8
    s_waitcnt vmcnt(12)
    v_perm_b32 v66, v148, v144, s36
    v_perm_b32 v70, v148, v144, s37
    v_perm_b32 v74, v149, v145, s36
    v_perm_b32 v78, v149, v145, s37
    v_perm_b32 v82, v150, v146, s36
    v_perm_b32 v86, v150, v146, s37
    v_perm_b32 v90, v151, v147, s36
    v_perm_b32 v94, v151, v147, s37
    s_waitcnt vmcnt(9)
    v_perm_b32 v67, v156, v152, s36
    v_perm_b32 v71, v156, v152, s37
    v_perm_b32 v75, v157, v153, s36
    v_mfma_f32_16x16x32_bf16 v[32:35], v[28:31], v[64:67], v[32:35]
    v_perm_b32 v79, v157, v153, s37
    v_mfma_f32_16x16x32_bf16 v[36:39], v[28:31], v[68:71], v[36:39]
    v_perm_b32 v83, v158, v154, s36
    v_mfma_f32_16x16x32_bf16 v[40:43], v[28:31], v[72:75], v[40:43]
    v_perm_b32 v87, v158, v154, s37
    v_mfma_f32_16x16x32_bf16 v[44:47], v[28:31], v[76:79], v[44:47]
    v_perm_b32 v91, v159, v155, s36
    v_mfma_f32_16x16x32_bf16 v[48:51], v[28:31], v[80:83], v[48:51]
    v_perm_b32 v95, v159, v155, s37
    v_mfma_f32_16x16x32_bf16 v[52:55], v[28:31], v[84:87], v[52:55]
    v_mfma_f32_16x16x32_bf16 v[56:59], v[28:31], v[88:91], v[56:59]
    v_mfma_f32_16x16x32_bf16 v[60:63], v[28:31], v[92:95], v[60:63]
    s_waitcnt vmcnt(7)
    v_perm_b32 v64, v100, v96, s36
    v_perm_b32 v68, v100, v96, s37
    v_perm_b32 v72, v101, v97, s36
    v_perm_b32 v76, v101, v97, s37
    v_perm_b32 v80, v102, v98, s36
    v_perm_b32 v84, v102, v98, s37
    v_perm_b32 v88, v103, v99, s36
    v_perm_b32 v92, v103, v99, s37
    s_waitcnt vmcnt(5)
    v_perm_b32 v65, v108, v104, s36
    v_perm_b32 v69, v108, v104, s37
    v_perm_b32 v73, v109, v105, s36
    v_perm_b32 v77, v109, v105, s37
    v_perm_b32 v81, v110, v106, s36
    v_perm_b32 v85, v110, v106, s37
    v_perm_b32 v89, v111, v107, s36
    v_perm_b32 v93, v111, v107, s37
    s_waitcnt vmcnt(3)
    v_perm_b32 v66, v116, v112, s36
    v_perm_b32 v70, v116, v112, s37
    v_perm_b32 v74, v117, v113, s36
    v_perm_b32 v78, v117, v113, s37
    v_perm_b32 v82, v118, v114, s36
    v_perm_b32 v86, v118, v114, s37
    v_perm_b32 v90, v119, v115, s36
    v_perm_b32 v94, v119, v115, s37
    s_waitcnt vmcnt(0)
    v_perm_b32 v67, v124, v120, s36
    v_perm_b32 v71, v124, v120, s37
    v_perm_b32 v75, v125, v121, s36
    v_mfma_f32_16x16x32_bf16 v[32:35], v[24:27], v[64:67], v[32:35]
    v_perm_b32 v79, v125, v121, s37
    v_mfma_f32_16x16x32_bf16 v[36:39], v[24:27], v[68:71], v[36:39]
    v_perm_b32 v83, v126, v122, s36
    v_mfma_f32_16x16x32_bf16 v[40:43], v[24:27], v[72:75], v[40:43]
    v_perm_b32 v87, v126, v122, s37
    v_mfma_f32_16x16x32_bf16 v[44:47], v[24:27], v[76:79], v[44:47]
    v_perm_b32 v91, v127, v123, s36
    v_mfma_f32_16x16x32_bf16 v[48:51], v[24:27], v[80:83], v[48:51]
    v_perm_b32 v95, v127, v123, s37
    v_mfma_f32_16x16x32_bf16 v[52:55], v[24:27], v[84:87], v[52:55]
    v_mfma_f32_16x16x32_bf16 v[56:59], v[24:27], v[88:91], v[56:59]
    v_mfma_f32_16x16x32_bf16 v[60:63], v[24:27], v[92:95], v[60:63]
L_epi:
    v_mov_b32 v177, s28
    v_mul_f32 v64, v20, v32
    v_fmac_f32 v64, v21, v33
    v_fmac_f32 v64, v22, v34
    v_fmac_f32 v64, v23, v35
    v_mul_f32 v65, v20, v36
    v_fmac_f32 v65, v21, v37
    v_fmac_f32 v65, v22, v38
    v_fmac_f32 v65, v23, v39
    v_mul_f32 v66, v20, v40
    v_fmac_f32 v66, v21, v41
    v_fmac_f32 v66, v22, v42
    v_fmac_f32 v66, v23, v43
    v_mul_f32 v67, v20, v44
    v_fmac_f32 v67, v21, v45
    v_fmac_f32 v67, v22, v46
    v_fmac_f32 v67, v23, v47
    v_mul_f32 v68, v20, v48
    v_fmac_f32 v68, v21, v49
    v_fmac_f32 v68, v22, v50
    v_fmac_f32 v68, v23, v51
    v_mul_f32 v69, v20, v52
    v_fmac_f32 v69, v21, v53
    v_fmac_f32 v69, v22, v54
    v_fmac_f32 v69, v23, v55
    v_mul_f32 v70, v20, v56
    v_fmac_f32 v70, v21, v57
    v_fmac_f32 v70, v22, v58
    v_fmac_f32 v70, v23, v59
    v_mul_f32 v71, v20, v60
    v_fmac_f32 v71, v21, v61
    v_fmac_f32 v71, v22, v62
    v_fmac_f32 v71, v23, v63
    v_mov_b32 v179, s28
    s_mov_b32 s62, 0
    v_permlane32_swap_b32 v64, v68
    v_permlane32_swap_b32 v65, v69
    v_permlane32_swap_b32 v66, v70
    v_permlane32_swap_b32 v67, v71
    v_add_f32 v64, v64, v68
    v_add_f32 v65, v65, v69
    v_add_f32 v66, v66, v70
    v_add_f32 v67, v67, v71
    s_nop 1
    v_permlane16_swap_b32 v64, v66
    v_permlane16_swap_b32 v65, v67
    v_add_f32 v176, v64, v66
    v_add_f32 v178, v65, v67
    buffer_store_dwordx4 v[176:179], v13, s[32:35], s60 offen sc1
    s_endpgm
L_col:
    v_and_b32 v73, 63, v0
    v_lshlrev_b32 v73, 2, v73
    s_nop 2
    v_mul_f32 v64, v20, v236
    v_fmac_f32 v64, v21, v237
    v_fmac_f32 v64, v22, v238
    v_fmac_f32 v64, v23, v239
    v_mul_f32 v65, v20, v240
    v_fmac_f32 v65, v21, v241
    v_fmac_f32 v65, v22, v242
    v_fmac_f32 v65, v23, v243
    v_mul_f32 v66, v20, v244
    v_fmac_f32 v66, v21, v245
    v_fmac_f32 v66, v22, v246
    v_fmac_f32 v66, v23, v247
    v_mul_f32 v67, v20, v248
    v_fmac_f32 v67, v21, v249
    v_fmac_f32 v67, v22, v250
    v_fmac_f32 v67, v23, v251
    s_nop 1
    v_permlane32_swap_b32 v64, v66
    v_permlane32_swap_b32 v65, v67
    v_add_f32 v64, v64, v66
    v_add_f32 v65, v65, v67
    s_nop 1
    v_permlane16_swap_b32 v64, v65
    v_add_f32 v64, v64, v65
    s_branch L_look
L_again:
    buffer_load_dwordx2 v[160:161], v14, s[32:35], s81 offen offset:0 sc1
    buffer_load_dwordx2 v[162:163], v14, s[32:35], s81 offen offset:2048 sc1
    buffer_load_dwordx2 v[164:165], v14, s[32:35], s82 offen offset:0 sc1
    buffer_load_dwordx2 v[166:167], v14, s[32:35], s82 offen offset:2048 sc1
L_look:
    s_add_u32 s62, s62, 1
    s_cmp_ge_u32 s62, 0x200000
    s_waitcnt vmcnt(0)
    v_xor_b32 v4, s28, v161
    v_xor_b32 v5, s28, v163
    v_bitop3_b32 v4, v4, v165, s28 bitop3:0xf6
    v_bitop3_b32 v5, v5, v167, s28 bitop3:0xf6
    v_or_b32 v4, v4, v5
    v_cmp_ne_u32 vcc, 0, v4
    s_cbranch_scc1 L_fin
    s_cbranch_vccnz L_again
L_fin:
    v_add_f32 v160, v160, v162
    v_add_f32 v164, v164, v166
    v_add_f32 v64, v64, v160
    s_cmp_eq_u32 s3, 0
    v_add_f32 v64, v64, v164
    s_cbranch_scc1 L_w0
    ds_write_b32 v73, v64
    s_waitcnt lgkmcnt(0)
    s_barrier
    s_endpgm
L_w0:
    s_barrier
    ds_read_b32 v65, v73
    s_waitcnt lgkmcnt(0)
    v_add_f32 v64, v64, v65
    v_cvt_pk_bf16_f32 v64, v64, v64
    buffer_store_short v64, v15, s[24:27], s80 offen
L_exit:
L_end:
    s_endpgm
L_evQ:
    buffer_load_dwordx4 v[164:167], v11, s[32:35], s75 offen sc1
    buffer_load_dwordx4 v[168:171], v11, s[32:35], s75 offen offset:16 sc1
    s_mov_b32 s62, 0
    s_branch L_v_back
L_retryQ:
    buffer_load_dwordx4 v[164:167], v11, s[32:35], s75 offen sc1
    buffer_load_dwordx4 v[168:171], v11, s[32:35], s75 offen offset:16 sc1
    s_add_u32 s62, s62, 1
    s_cmp_lt_u32 s62, 0x200000
    s_waitcnt vmcnt(0)
    s_cbranch_scc1 L_chkQ
L_last:
    s_branch L_okQ
.section .rodata,"a"
.p2align 6
.amdhsa_kernel standalone__low_rank_proj_linformer__decode_kernel
  .amdhsa_next_free_vgpr 252
  .amdhsa_next_free_sgpr 96
  .amdhsa_accum_offset 252
  .amdhsa_group_segment_fixed_size 0
  .amdhsa_kernarg_size 64
  .amdhsa_user_sgpr_count 2
  .amdhsa_user_sgpr_kernarg_segment_ptr 1
  .amdhsa_system_sgpr_workgroup_id_x 1
  .amdhsa_float_denorm_mode_32 3
.end_amdhsa_kernel
```
